```python
import torch

def _softmax(x, axis=-1):
    return torch.softmax(x, dim=axis)

def _gelu(x):
    return torch.nn.functional.gelu(x, approximate='tanh')

def _silu(x):
    return torch.nn.functional.silu(x)

def _sigmoid(x):
    return torch.sigmoid(x)

def _layernorm(x, axis=-1, eps=1e-05):
    m = x.mean(dim=axis, keepdim=True)
    v = x.var(dim=axis, keepdim=True, unbiased=False)
    return (x - m) / torch.sqrt(v + eps)

def _scatter_add(tgt, idx, src, axis=0):
    return tgt.clone().index_add_(axis, idx, src)

def _segment_sum(src, seg, n):
    out = torch.zeros((n,) + src.shape[1:], dtype=src.dtype)
    return out.index_add_(0, seg, src)

def _pad(x, pw):
    flat = tuple((v for pair in reversed(pw) for v in pair))
    return torch.nn.functional.pad(x, flat)
kernel_name = 'standalone__molecular_angular_painn__graph'

def setup_inputs():

    _w = lambda a: (lambda t: t.to(torch.bfloat16) if t.is_floating_point() else t)(torch.as_tensor(a))
    N, deg, D = (25000, 16, 128)
    n_rbf = max(16, 4)
    E = N * deg
    cutoff = 5.0
    freqs = (torch.arange(1, n_rbf + 1) * torch.pi / cutoff).to(float)
    return {'sv': _w((lambda *s: torch.randn(*s, dtype=torch.bfloat16) * 0.4)(N, 4, D) * 0.3), 'pos': _w((lambda *s: torch.randn(*s, dtype=torch.bfloat16) * 3.2)(N, 3) * 1.2), 'src': _w((lambda lo, hi, *s: torch.randint(lo, hi, s))(0, N, E).to(torch.int64)), 'dst': _w((lambda lo, hi, *s: torch.randint(lo, hi, s))(0, N, E).to(torch.int64)), 'freqs': _w(freqs), 'w_phi1': _w((lambda *s: torch.randn(*s, dtype=torch.bfloat16) * 3.2)(D, D) / D ** 0.5), 'w_phi2': _w((lambda *s: torch.randn(*s, dtype=torch.bfloat16) * 3.2)(D, 3 * D) / D ** 0.5), 'w_rbf': _w((lambda *s: torch.randn(*s, dtype=torch.bfloat16) * 3.2)(n_rbf, 3 * D) / n_rbf ** 0.5)}

def reference(sv, pos, src, dst, freqs, w_phi1, w_phi2, w_rbf):
    N, _, D = sv.shape
    E = src.shape[0]
    PI, cutoff = (3.141592653589793, 5.0)
    s, v = (sv[:, 0, :].clone(), sv[:, 1:, :].clone())
    r_vec = pos[src] - pos[dst]
    d = torch.sqrt((r_vec * r_vec).sum(-1) + 1e-08)
    r_hat = r_vec / d[:, None]
    rbf = torch.sin(d[:, None] * freqs[None, :]) / d[:, None]
    fcut = 0.5 * (torch.cos(PI * d / cutoff) + 1.0)
    fcut = torch.where(d < cutoff, fcut, 0.0 * d)
    Wf = rbf @ w_rbf * fcut[:, None]
    phi = (_silu(s @ w_phi1) @ w_phi2)[src]
    m = phi * Wf
    m_s, m_vv, m_vr = (m[:, :D].clone(), m[:, D:2 * D].clone(), m[:, 2 * D:].clone())
    ds = _segment_sum(m_s, dst, N)
    dv_e = m_vv[:, None, :] * v[src] + m_vr[:, None, :] * r_hat[:, :, None]
    dv = _segment_sum(dv_e.reshape(E, 3 * D), dst, N).reshape(N, 3, D)
    return sv + torch.concatenate([ds[:, None, :], dv], axis=1)
```

```asm
; @launch kernel=k0_kernel grid=(256,1,1) block=(256,1,1) lds=0
; @launch kernel=k1_kernel grid=(1759,1,1) block=(256,1,1) lds=0
; @launch kernel=standalone__molecular_angular_painn__graph_kernel grid=(6250,1,1) block=(256,1,1) lds=0
.amdgcn_target "amdgcn-amd-amdhsa--gfx950"
.text
.macro RND2 a, b, t
    v_cvt_pk_bf16_f32 \t, \a, \b
    v_lshlrev_b32 \a, 16, \t
    v_and_b32 \b, 0xffff0000, \t
.endm
.macro SRD d, p, off, sz
    s_add_u32 s[\d], s[\p], \off
    s_addc_u32 s[\d+1], s[\p+1], 0
    s_mov_b32 s[\d+2], \sz
    s_mov_b32 s[\d+3], 0x00020000
.endm
.globl k0_kernel
.p2align 8
.type k0_kernel,@function
k0_kernel:
    s_cmp_ge_u32 s2, 256
    s_cbranch_scc1 k0_end
    s_load_dwordx2 s[4:5], s[0:1], 40
    s_load_dwordx2 s[6:7], s[0:1], 48
    s_load_dwordx2 s[8:9], s[0:1], 56
    s_load_dwordx2 s[10:11], s[0:1], 80
    s_waitcnt lgkmcnt(0)
    SRD 12, 4, 0, 32768
    SRD 16, 6, 0, 98304
    SRD 20, 8, 0, 12288
    SRD 24, 10, 0, 0x10000000
    s_lshl_b32 s3, s2, 8
    v_add_u32 v1, s3, v0
    v_lshlrev_b32 v2, 2, v1
    v_mov_b32 v3, -1
    v_cmp_gt_u32 vcc, 25000, v1
    s_and_saveexec_b64 s[30:31], vcc
    buffer_store_dword v3, v2, s[24:27], 0 offen
    s_mov_b64 exec, s[30:31]
    v_lshrrev_b32 v4, 7, v1
    v_and_b32 v5, 127, v1
    v_lshlrev_b32 v6, 8, v5
    v_lshl_add_u32 v6, v4, 1, v6
    v_cmp_gt_u32 vcc, 128, v4
    s_and_saveexec_b64 s[30:31], vcc
    buffer_load_ushort v7, v6, s[12:15], 0 offen
    v_lshlrev_b32 v8, 1, v1
    v_add_u32 v8, 0x20000, v8
    s_waitcnt vmcnt(0)
    buffer_store_short v7, v8, s[24:27], 0 offen
    s_mov_b64 exec, s[30:31]
    v_subrev_u32 v9, 128, v4
    v_and_b32 v10, 7, v5
    v_bfe_u32 v11, v5, 3, 1
    v_and_b32 v12, 3, v10
    v_lshl_add_u32 v12, v11, 2, v12
    v_lshrrev_b32 v13, 2, v10
    v_lshl_add_u32 v12, v13, 3, v12
    v_and_b32 v13, 0x70, v5
    v_add_u32 v12, v13, v12
    v_mul_u32_u24 v12, 768, v12
    v_lshl_add_u32 v12, v9, 1, v12
    v_cmp_le_u32 vcc, 128, v4
    s_and_saveexec_b64 s[30:31], vcc
    buffer_load_ushort v7, v12, s[16:19], 0 offen
    v_lshlrev_b32 v8, 1, v1
    v_add_u32 v8, 0x20000, v8
    s_waitcnt vmcnt(0)
    buffer_store_short v7, v8, s[24:27], 0 offen
    s_mov_b64 exec, s[30:31]
    v_lshrrev_b32 v4, 9, v1
    v_and_b32 v5, 511, v1
    v_cmp_gt_u32 vcc, 384, v5
    v_cmp_gt_u32 s[32:33], 8, v4
    s_and_b64 vcc, vcc, s[32:33]
    s_and_saveexec_b64 s[30:31], vcc
    s_cbranch_execz k0_end
    v_mul_u32_u24 v6, 1536, v4
    v_lshl_add_u32 v6, v5, 1, v6
    buffer_load_ushort v7, v6, s[20:23], 0 offen
    buffer_load_ushort v8, v6, s[20:23], 0 offen offset:768
    v_mul_u32_u24 v6, 1536, v4
    v_lshl_add_u32 v6, v5, 2, v6
    v_add_u32 v6, 0x40000, v6
    s_waitcnt vmcnt(0)
    v_lshl_or_b32 v7, v8, 16, v7
    buffer_store_dword v7, v6, s[24:27], 0 offen
k0_end:
    s_endpgm
.globl k1_kernel
.p2align 8
.type k1_kernel,@function
k1_kernel:
    s_cmp_ge_u32 s2, 1759
    s_cbranch_scc1 k1_end
    s_load_dwordx2 s[4:5], s[0:1], 0
    s_load_dwordx2 s[6:7], s[0:1], 8
    s_load_dwordx2 s[8:9], s[0:1], 16
    s_load_dwordx2 s[10:11], s[0:1], 24
    s_load_dwordx2 s[36:37], s[0:1], 32
    s_load_dwordx2 s[38:39], s[0:1], 80
    s_waitcnt lgkmcnt(0)
    s_load_dwordx8 s[40:47], s[36:37], 0
    SRD 12, 4, 0, 25600000
    SRD 16, 6, 0, 150000
    SRD 20, 8, 0, 1600000
    SRD 24, 10, 0, 1600000
    SRD 28, 38, 0, 0x10000000
    s_cmp_ge_u32 s2, 196
    s_cbranch_scc1 k1_edges
    v_lshrrev_b32 v1, 6, v0
    s_lshl_b32 s3, s2, 2
    v_add_u32 v1, s3, v1
    v_and_b32 v2, 31, v0
    v_bfe_u32 v3, v0, 5, 1
    v_lshl_add_u32 v4, v1, 5, v2
    v_lshlrev_b32 v5, 10, v4
    v_lshl_add_u32 v5, v3, 4, v5
    v_lshlrev_b32 v6, 8, v2
    v_lshl_add_u32 v6, v3, 4, v6
    v_add_u32 v6, 0x20000, v6
    buffer_load_dwordx4 v[16:19], v5, s[12:15], 0 offen offset:0
    buffer_load_dwordx4 v[20:23], v5, s[12:15], 0 offen offset:32
    buffer_load_dwordx4 v[24:27], v5, s[12:15], 0 offen offset:64
    buffer_load_dwordx4 v[28:31], v5, s[12:15], 0 offen offset:96
    buffer_load_dwordx4 v[32:35], v5, s[12:15], 0 offen offset:128
    buffer_load_dwordx4 v[36:39], v5, s[12:15], 0 offen offset:160
    buffer_load_dwordx4 v[40:43], v5, s[12:15], 0 offen offset:192
    buffer_load_dwordx4 v[44:47], v5, s[12:15], 0 offen offset:224
    v_mov_b32 v64, 0
    v_mov_b32 v65, 0
    v_mov_b32 v66, 0
    v_mov_b32 v67, 0
    v_mov_b32 v68, 0
    v_mov_b32 v69, 0
    v_mov_b32 v70, 0
    v_mov_b32 v71, 0
    v_mov_b32 v72, 0
    v_mov_b32 v73, 0
    v_mov_b32 v74, 0
    v_mov_b32 v75, 0
    v_mov_b32 v76, 0
    v_mov_b32 v77, 0
    v_mov_b32 v78, 0
    v_mov_b32 v79, 0
    v_mov_b32 v80, 0
    v_mov_b32 v81, 0
    v_mov_b32 v82, 0
    v_mov_b32 v83, 0
    v_mov_b32 v84, 0
    v_mov_b32 v85, 0
    v_mov_b32 v86, 0
    v_mov_b32 v87, 0
    v_mov_b32 v88, 0
    v_mov_b32 v89, 0
    v_mov_b32 v90, 0
    v_mov_b32 v91, 0
    v_mov_b32 v92, 0
    v_mov_b32 v93, 0
    v_mov_b32 v94, 0
    v_mov_b32 v95, 0
    v_mov_b32 v96, 0
    v_mov_b32 v97, 0
    v_mov_b32 v98, 0
    v_mov_b32 v99, 0
    v_mov_b32 v100, 0
    v_mov_b32 v101, 0
    v_mov_b32 v102, 0
    v_mov_b32 v103, 0
    v_mov_b32 v104, 0
    v_mov_b32 v105, 0
    v_mov_b32 v106, 0
    v_mov_b32 v107, 0
    v_mov_b32 v108, 0
    v_mov_b32 v109, 0
    v_mov_b32 v110, 0
    v_mov_b32 v111, 0
    v_mov_b32 v112, 0
    v_mov_b32 v113, 0
    v_mov_b32 v114, 0
    v_mov_b32 v115, 0
    v_mov_b32 v116, 0
    v_mov_b32 v117, 0
    v_mov_b32 v118, 0
    v_mov_b32 v119, 0
    v_mov_b32 v120, 0
    v_mov_b32 v121, 0
    v_mov_b32 v122, 0
    v_mov_b32 v123, 0
    v_mov_b32 v124, 0
    v_mov_b32 v125, 0
    v_mov_b32 v126, 0
    v_mov_b32 v127, 0
    s_mov_b32 s48, 0
    buffer_load_dwordx4 v[128:131], v6, s[28:31], s48 offen offset:0
    buffer_load_dwordx4 v[132:135], v6, s[28:31], s48 offen offset:32
    buffer_load_dwordx4 v[136:139], v6, s[28:31], s48 offen offset:64
    buffer_load_dwordx4 v[140:143], v6, s[28:31], s48 offen offset:96
    buffer_load_dwordx4 v[144:147], v6, s[28:31], s48 offen offset:128
    buffer_load_dwordx4 v[148:151], v6, s[28:31], s48 offen offset:160
    buffer_load_dwordx4 v[152:155], v6, s[28:31], s48 offen offset:192
    buffer_load_dwordx4 v[156:159], v6, s[28:31], s48 offen offset:224
    s_waitcnt vmcnt(0)
    v_mfma_f32_32x32x16_bf16 v[64:79], v[128:131], v[16:19], v[64:79]
    v_mfma_f32_32x32x16_bf16 v[64:79], v[132:135], v[20:23], v[64:79]
    v_mfma_f32_32x32x16_bf16 v[64:79], v[136:139], v[24:27], v[64:79]
    v_mfma_f32_32x32x16_bf16 v[64:79], v[140:143], v[28:31], v[64:79]
    v_mfma_f32_32x32x16_bf16 v[64:79], v[144:147], v[32:35], v[64:79]
    v_mfma_f32_32x32x16_bf16 v[64:79], v[148:151], v[36:39], v[64:79]
    v_mfma_f32_32x32x16_bf16 v[64:79], v[152:155], v[40:43], v[64:79]
    v_mfma_f32_32x32x16_bf16 v[64:79], v[156:159], v[44:47], v[64:79]
    s_mov_b32 s48, 8192
    buffer_load_dwordx4 v[128:131], v6, s[28:31], s48 offen offset:0
    buffer_load_dwordx4 v[132:135], v6, s[28:31], s48 offen offset:32
    buffer_load_dwordx4 v[136:139], v6, s[28:31], s48 offen offset:64
    buffer_load_dwordx4 v[140:143], v6, s[28:31], s48 offen offset:96
    buffer_load_dwordx4 v[144:147], v6, s[28:31], s48 offen offset:128
    buffer_load_dwordx4 v[148:151], v6, s[28:31], s48 offen offset:160
    buffer_load_dwordx4 v[152:155], v6, s[28:31], s48 offen offset:192
    buffer_load_dwordx4 v[156:159], v6, s[28:31], s48 offen offset:224
    s_waitcnt vmcnt(0)
    v_mfma_f32_32x32x16_bf16 v[80:95], v[128:131], v[16:19], v[80:95]
    v_mfma_f32_32x32x16_bf16 v[80:95], v[132:135], v[20:23], v[80:95]
    v_mfma_f32_32x32x16_bf16 v[80:95], v[136:139], v[24:27], v[80:95]
    v_mfma_f32_32x32x16_bf16 v[80:95], v[140:143], v[28:31], v[80:95]
    v_mfma_f32_32x32x16_bf16 v[80:95], v[144:147], v[32:35], v[80:95]
    v_mfma_f32_32x32x16_bf16 v[80:95], v[148:151], v[36:39], v[80:95]
    v_mfma_f32_32x32x16_bf16 v[80:95], v[152:155], v[40:43], v[80:95]
    v_mfma_f32_32x32x16_bf16 v[80:95], v[156:159], v[44:47], v[80:95]
    s_mov_b32 s48, 16384
    buffer_load_dwordx4 v[128:131], v6, s[28:31], s48 offen offset:0
    buffer_load_dwordx4 v[132:135], v6, s[28:31], s48 offen offset:32
    buffer_load_dwordx4 v[136:139], v6, s[28:31], s48 offen offset:64
    buffer_load_dwordx4 v[140:143], v6, s[28:31], s48 offen offset:96
    buffer_load_dwordx4 v[144:147], v6, s[28:31], s48 offen offset:128
    buffer_load_dwordx4 v[148:151], v6, s[28:31], s48 offen offset:160
    buffer_load_dwordx4 v[152:155], v6, s[28:31], s48 offen offset:192
    buffer_load_dwordx4 v[156:159], v6, s[28:31], s48 offen offset:224
    s_waitcnt vmcnt(0)
    v_mfma_f32_32x32x16_bf16 v[96:111], v[128:131], v[16:19], v[96:111]
    v_mfma_f32_32x32x16_bf16 v[96:111], v[132:135], v[20:23], v[96:111]
    v_mfma_f32_32x32x16_bf16 v[96:111], v[136:139], v[24:27], v[96:111]
    v_mfma_f32_32x32x16_bf16 v[96:111], v[140:143], v[28:31], v[96:111]
    v_mfma_f32_32x32x16_bf16 v[96:111], v[144:147], v[32:35], v[96:111]
    v_mfma_f32_32x32x16_bf16 v[96:111], v[148:151], v[36:39], v[96:111]
    v_mfma_f32_32x32x16_bf16 v[96:111], v[152:155], v[40:43], v[96:111]
    v_mfma_f32_32x32x16_bf16 v[96:111], v[156:159], v[44:47], v[96:111]
    s_mov_b32 s48, 24576
    buffer_load_dwordx4 v[128:131], v6, s[28:31], s48 offen offset:0
    buffer_load_dwordx4 v[132:135], v6, s[28:31], s48 offen offset:32
    buffer_load_dwordx4 v[136:139], v6, s[28:31], s48 offen offset:64
    buffer_load_dwordx4 v[140:143], v6, s[28:31], s48 offen offset:96
    buffer_load_dwordx4 v[144:147], v6, s[28:31], s48 offen offset:128
    buffer_load_dwordx4 v[148:151], v6, s[28:31], s48 offen offset:160
    buffer_load_dwordx4 v[152:155], v6, s[28:31], s48 offen offset:192
    buffer_load_dwordx4 v[156:159], v6, s[28:31], s48 offen offset:224
    s_waitcnt vmcnt(0)
    v_mfma_f32_32x32x16_bf16 v[112:127], v[128:131], v[16:19], v[112:127]
    v_mfma_f32_32x32x16_bf16 v[112:127], v[132:135], v[20:23], v[112:127]
    v_mfma_f32_32x32x16_bf16 v[112:127], v[136:139], v[24:27], v[112:127]
    v_mfma_f32_32x32x16_bf16 v[112:127], v[140:143], v[28:31], v[112:127]
    v_mfma_f32_32x32x16_bf16 v[112:127], v[144:147], v[32:35], v[112:127]
    v_mfma_f32_32x32x16_bf16 v[112:127], v[148:151], v[36:39], v[112:127]
    v_mfma_f32_32x32x16_bf16 v[112:127], v[152:155], v[40:43], v[112:127]
    v_mfma_f32_32x32x16_bf16 v[112:127], v[156:159], v[44:47], v[112:127]
    s_nop 15
    s_nop 7
    RND2 v64, v65, v8
    v_mul_f32 v9, 0xbfb8aa3b, v64
    v_exp_f32 v9, v9
    s_nop 0
    v_add_f32 v9, 1.0, v9
    v_rcp_f32 v9, v9
    s_nop 0
    v_mul_f32 v64, v64, v9
    v_mul_f32 v9, 0xbfb8aa3b, v65
    v_exp_f32 v9, v9
    s_nop 0
    v_add_f32 v9, 1.0, v9
    v_rcp_f32 v9, v9
    s_nop 0
    v_mul_f32 v65, v65, v9
    v_cvt_pk_bf16_f32 v16, v64, v65
    RND2 v66, v67, v8
    v_mul_f32 v9, 0xbfb8aa3b, v66
    v_exp_f32 v9, v9
    s_nop 0
    v_add_f32 v9, 1.0, v9
    v_rcp_f32 v9, v9
    s_nop 0
    v_mul_f32 v66, v66, v9
    v_mul_f32 v9, 0xbfb8aa3b, v67
    v_exp_f32 v9, v9
    s_nop 0
    v_add_f32 v9, 1.0, v9
    v_rcp_f32 v9, v9
    s_nop 0
    v_mul_f32 v67, v67, v9
    v_cvt_pk_bf16_f32 v17, v66, v67
    RND2 v68, v69, v8
    v_mul_f32 v9, 0xbfb8aa3b, v68
    v_exp_f32 v9, v9
    s_nop 0
    v_add_f32 v9, 1.0, v9
    v_rcp_f32 v9, v9
    s_nop 0
    v_mul_f32 v68, v68, v9
    v_mul_f32 v9, 0xbfb8aa3b, v69
    v_exp_f32 v9, v9
    s_nop 0
    v_add_f32 v9, 1.0, v9
    v_rcp_f32 v9, v9
    s_nop 0
    v_mul_f32 v69, v69, v9
    v_cvt_pk_bf16_f32 v18, v68, v69
    RND2 v70, v71, v8
    v_mul_f32 v9, 0xbfb8aa3b, v70
    v_exp_f32 v9, v9
    s_nop 0
    v_add_f32 v9, 1.0, v9
    v_rcp_f32 v9, v9
    s_nop 0
    v_mul_f32 v70, v70, v9
    v_mul_f32 v9, 0xbfb8aa3b, v71
    v_exp_f32 v9, v9
    s_nop 0
    v_add_f32 v9, 1.0, v9
    v_rcp_f32 v9, v9
    s_nop 0
    v_mul_f32 v71, v71, v9
    v_cvt_pk_bf16_f32 v19, v70, v71
    RND2 v72, v73, v8
    v_mul_f32 v9, 0xbfb8aa3b, v72
    v_exp_f32 v9, v9
    s_nop 0
    v_add_f32 v9, 1.0, v9
    v_rcp_f32 v9, v9
    s_nop 0
    v_mul_f32 v72, v72, v9
    v_mul_f32 v9, 0xbfb8aa3b, v73
    v_exp_f32 v9, v9
    s_nop 0
    v_add_f32 v9, 1.0, v9
    v_rcp_f32 v9, v9
    s_nop 0
    v_mul_f32 v73, v73, v9
    v_cvt_pk_bf16_f32 v20, v72, v73
    RND2 v74, v75, v8
    v_mul_f32 v9, 0xbfb8aa3b, v74
    v_exp_f32 v9, v9
    s_nop 0
    v_add_f32 v9, 1.0, v9
    v_rcp_f32 v9, v9
    s_nop 0
    v_mul_f32 v74, v74, v9
    v_mul_f32 v9, 0xbfb8aa3b, v75
    v_exp_f32 v9, v9
    s_nop 0
    v_add_f32 v9, 1.0, v9
    v_rcp_f32 v9, v9
    s_nop 0
    v_mul_f32 v75, v75, v9
    v_cvt_pk_bf16_f32 v21, v74, v75
    RND2 v76, v77, v8
    v_mul_f32 v9, 0xbfb8aa3b, v76
    v_exp_f32 v9, v9
    s_nop 0
    v_add_f32 v9, 1.0, v9
    v_rcp_f32 v9, v9
    s_nop 0
    v_mul_f32 v76, v76, v9
    v_mul_f32 v9, 0xbfb8aa3b, v77
    v_exp_f32 v9, v9
    s_nop 0
    v_add_f32 v9, 1.0, v9
    v_rcp_f32 v9, v9
    s_nop 0
    v_mul_f32 v77, v77, v9
    v_cvt_pk_bf16_f32 v22, v76, v77
    RND2 v78, v79, v8
    v_mul_f32 v9, 0xbfb8aa3b, v78
    v_exp_f32 v9, v9
    s_nop 0
    v_add_f32 v9, 1.0, v9
    v_rcp_f32 v9, v9
    s_nop 0
    v_mul_f32 v78, v78, v9
    v_mul_f32 v9, 0xbfb8aa3b, v79
    v_exp_f32 v9, v9
    s_nop 0
    v_add_f32 v9, 1.0, v9
    v_rcp_f32 v9, v9
    s_nop 0
    v_mul_f32 v79, v79, v9
    v_cvt_pk_bf16_f32 v23, v78, v79
    RND2 v80, v81, v8
    v_mul_f32 v9, 0xbfb8aa3b, v80
    v_exp_f32 v9, v9
    s_nop 0
    v_add_f32 v9, 1.0, v9
    v_rcp_f32 v9, v9
    s_nop 0
    v_mul_f32 v80, v80, v9
    v_mul_f32 v9, 0xbfb8aa3b, v81
    v_exp_f32 v9, v9
    s_nop 0
    v_add_f32 v9, 1.0, v9
    v_rcp_f32 v9, v9
    s_nop 0
    v_mul_f32 v81, v81, v9
    v_cvt_pk_bf16_f32 v24, v80, v81
    RND2 v82, v83, v8
    v_mul_f32 v9, 0xbfb8aa3b, v82
    v_exp_f32 v9, v9
    s_nop 0
    v_add_f32 v9, 1.0, v9
    v_rcp_f32 v9, v9
    s_nop 0
    v_mul_f32 v82, v82, v9
    v_mul_f32 v9, 0xbfb8aa3b, v83
    v_exp_f32 v9, v9
    s_nop 0
    v_add_f32 v9, 1.0, v9
    v_rcp_f32 v9, v9
    s_nop 0
    v_mul_f32 v83, v83, v9
    v_cvt_pk_bf16_f32 v25, v82, v83
    RND2 v84, v85, v8
    v_mul_f32 v9, 0xbfb8aa3b, v84
    v_exp_f32 v9, v9
    s_nop 0
    v_add_f32 v9, 1.0, v9
    v_rcp_f32 v9, v9
    s_nop 0
    v_mul_f32 v84, v84, v9
    v_mul_f32 v9, 0xbfb8aa3b, v85
    v_exp_f32 v9, v9
    s_nop 0
    v_add_f32 v9, 1.0, v9
    v_rcp_f32 v9, v9
    s_nop 0
    v_mul_f32 v85, v85, v9
    v_cvt_pk_bf16_f32 v26, v84, v85
    RND2 v86, v87, v8
    v_mul_f32 v9, 0xbfb8aa3b, v86
    v_exp_f32 v9, v9
    s_nop 0
    v_add_f32 v9, 1.0, v9
    v_rcp_f32 v9, v9
    s_nop 0
    v_mul_f32 v86, v86, v9
    v_mul_f32 v9, 0xbfb8aa3b, v87
    v_exp_f32 v9, v9
    s_nop 0
    v_add_f32 v9, 1.0, v9
    v_rcp_f32 v9, v9
    s_nop 0
    v_mul_f32 v87, v87, v9
    v_cvt_pk_bf16_f32 v27, v86, v87
    RND2 v88, v89, v8
    v_mul_f32 v9, 0xbfb8aa3b, v88
    v_exp_f32 v9, v9
    s_nop 0
    v_add_f32 v9, 1.0, v9
    v_rcp_f32 v9, v9
    s_nop 0
    v_mul_f32 v88, v88, v9
    v_mul_f32 v9, 0xbfb8aa3b, v89
    v_exp_f32 v9, v9
    s_nop 0
    v_add_f32 v9, 1.0, v9
    v_rcp_f32 v9, v9
    s_nop 0
    v_mul_f32 v89, v89, v9
    v_cvt_pk_bf16_f32 v28, v88, v89
    RND2 v90, v91, v8
    v_mul_f32 v9, 0xbfb8aa3b, v90
    v_exp_f32 v9, v9
    s_nop 0
    v_add_f32 v9, 1.0, v9
    v_rcp_f32 v9, v9
    s_nop 0
    v_mul_f32 v90, v90, v9
    v_mul_f32 v9, 0xbfb8aa3b, v91
    v_exp_f32 v9, v9
    s_nop 0
    v_add_f32 v9, 1.0, v9
    v_rcp_f32 v9, v9
    s_nop 0
    v_mul_f32 v91, v91, v9
    v_cvt_pk_bf16_f32 v29, v90, v91
    RND2 v92, v93, v8
    v_mul_f32 v9, 0xbfb8aa3b, v92
    v_exp_f32 v9, v9
    s_nop 0
    v_add_f32 v9, 1.0, v9
    v_rcp_f32 v9, v9
    s_nop 0
    v_mul_f32 v92, v92, v9
    v_mul_f32 v9, 0xbfb8aa3b, v93
    v_exp_f32 v9, v9
    s_nop 0
    v_add_f32 v9, 1.0, v9
    v_rcp_f32 v9, v9
    s_nop 0
    v_mul_f32 v93, v93, v9
    v_cvt_pk_bf16_f32 v30, v92, v93
    RND2 v94, v95, v8
    v_mul_f32 v9, 0xbfb8aa3b, v94
    v_exp_f32 v9, v9
    s_nop 0
    v_add_f32 v9, 1.0, v9
    v_rcp_f32 v9, v9
    s_nop 0
    v_mul_f32 v94, v94, v9
    v_mul_f32 v9, 0xbfb8aa3b, v95
    v_exp_f32 v9, v9
    s_nop 0
    v_add_f32 v9, 1.0, v9
    v_rcp_f32 v9, v9
    s_nop 0
    v_mul_f32 v95, v95, v9
    v_cvt_pk_bf16_f32 v31, v94, v95
    RND2 v96, v97, v8
    v_mul_f32 v9, 0xbfb8aa3b, v96
    v_exp_f32 v9, v9
    s_nop 0
    v_add_f32 v9, 1.0, v9
    v_rcp_f32 v9, v9
    s_nop 0
    v_mul_f32 v96, v96, v9
    v_mul_f32 v9, 0xbfb8aa3b, v97
    v_exp_f32 v9, v9
    s_nop 0
    v_add_f32 v9, 1.0, v9
    v_rcp_f32 v9, v9
    s_nop 0
    v_mul_f32 v97, v97, v9
    v_cvt_pk_bf16_f32 v32, v96, v97
    RND2 v98, v99, v8
    v_mul_f32 v9, 0xbfb8aa3b, v98
    v_exp_f32 v9, v9
    s_nop 0
    v_add_f32 v9, 1.0, v9
    v_rcp_f32 v9, v9
    s_nop 0
    v_mul_f32 v98, v98, v9
    v_mul_f32 v9, 0xbfb8aa3b, v99
    v_exp_f32 v9, v9
    s_nop 0
    v_add_f32 v9, 1.0, v9
    v_rcp_f32 v9, v9
    s_nop 0
    v_mul_f32 v99, v99, v9
    v_cvt_pk_bf16_f32 v33, v98, v99
    RND2 v100, v101, v8
    v_mul_f32 v9, 0xbfb8aa3b, v100
    v_exp_f32 v9, v9
    s_nop 0
    v_add_f32 v9, 1.0, v9
    v_rcp_f32 v9, v9
    s_nop 0
    v_mul_f32 v100, v100, v9
    v_mul_f32 v9, 0xbfb8aa3b, v101
    v_exp_f32 v9, v9
    s_nop 0
    v_add_f32 v9, 1.0, v9
    v_rcp_f32 v9, v9
    s_nop 0
    v_mul_f32 v101, v101, v9
    v_cvt_pk_bf16_f32 v34, v100, v101
    RND2 v102, v103, v8
    v_mul_f32 v9, 0xbfb8aa3b, v102
    v_exp_f32 v9, v9
    s_nop 0
    v_add_f32 v9, 1.0, v9
    v_rcp_f32 v9, v9
    s_nop 0
    v_mul_f32 v102, v102, v9
    v_mul_f32 v9, 0xbfb8aa3b, v103
    v_exp_f32 v9, v9
    s_nop 0
    v_add_f32 v9, 1.0, v9
    v_rcp_f32 v9, v9
    s_nop 0
    v_mul_f32 v103, v103, v9
    v_cvt_pk_bf16_f32 v35, v102, v103
    RND2 v104, v105, v8
    v_mul_f32 v9, 0xbfb8aa3b, v104
    v_exp_f32 v9, v9
    s_nop 0
    v_add_f32 v9, 1.0, v9
    v_rcp_f32 v9, v9
    s_nop 0
    v_mul_f32 v104, v104, v9
    v_mul_f32 v9, 0xbfb8aa3b, v105
    v_exp_f32 v9, v9
    s_nop 0
    v_add_f32 v9, 1.0, v9
    v_rcp_f32 v9, v9
    s_nop 0
    v_mul_f32 v105, v105, v9
    v_cvt_pk_bf16_f32 v36, v104, v105
    RND2 v106, v107, v8
    v_mul_f32 v9, 0xbfb8aa3b, v106
    v_exp_f32 v9, v9
    s_nop 0
    v_add_f32 v9, 1.0, v9
    v_rcp_f32 v9, v9
    s_nop 0
    v_mul_f32 v106, v106, v9
    v_mul_f32 v9, 0xbfb8aa3b, v107
    v_exp_f32 v9, v9
    s_nop 0
    v_add_f32 v9, 1.0, v9
    v_rcp_f32 v9, v9
    s_nop 0
    v_mul_f32 v107, v107, v9
    v_cvt_pk_bf16_f32 v37, v106, v107
    RND2 v108, v109, v8
    v_mul_f32 v9, 0xbfb8aa3b, v108
    v_exp_f32 v9, v9
    s_nop 0
    v_add_f32 v9, 1.0, v9
    v_rcp_f32 v9, v9
    s_nop 0
    v_mul_f32 v108, v108, v9
    v_mul_f32 v9, 0xbfb8aa3b, v109
    v_exp_f32 v9, v9
    s_nop 0
    v_add_f32 v9, 1.0, v9
    v_rcp_f32 v9, v9
    s_nop 0
    v_mul_f32 v109, v109, v9
    v_cvt_pk_bf16_f32 v38, v108, v109
    RND2 v110, v111, v8
    v_mul_f32 v9, 0xbfb8aa3b, v110
    v_exp_f32 v9, v9
    s_nop 0
    v_add_f32 v9, 1.0, v9
    v_rcp_f32 v9, v9
    s_nop 0
    v_mul_f32 v110, v110, v9
    v_mul_f32 v9, 0xbfb8aa3b, v111
    v_exp_f32 v9, v9
    s_nop 0
    v_add_f32 v9, 1.0, v9
    v_rcp_f32 v9, v9
    s_nop 0
    v_mul_f32 v111, v111, v9
    v_cvt_pk_bf16_f32 v39, v110, v111
    RND2 v112, v113, v8
    v_mul_f32 v9, 0xbfb8aa3b, v112
    v_exp_f32 v9, v9
    s_nop 0
    v_add_f32 v9, 1.0, v9
    v_rcp_f32 v9, v9
    s_nop 0
    v_mul_f32 v112, v112, v9
    v_mul_f32 v9, 0xbfb8aa3b, v113
    v_exp_f32 v9, v9
    s_nop 0
    v_add_f32 v9, 1.0, v9
    v_rcp_f32 v9, v9
    s_nop 0
    v_mul_f32 v113, v113, v9
    v_cvt_pk_bf16_f32 v40, v112, v113
    RND2 v114, v115, v8
    v_mul_f32 v9, 0xbfb8aa3b, v114
    v_exp_f32 v9, v9
    s_nop 0
    v_add_f32 v9, 1.0, v9
    v_rcp_f32 v9, v9
    s_nop 0
    v_mul_f32 v114, v114, v9
    v_mul_f32 v9, 0xbfb8aa3b, v115
    v_exp_f32 v9, v9
    s_nop 0
    v_add_f32 v9, 1.0, v9
    v_rcp_f32 v9, v9
    s_nop 0
    v_mul_f32 v115, v115, v9
    v_cvt_pk_bf16_f32 v41, v114, v115
    RND2 v116, v117, v8
    v_mul_f32 v9, 0xbfb8aa3b, v116
    v_exp_f32 v9, v9
    s_nop 0
    v_add_f32 v9, 1.0, v9
    v_rcp_f32 v9, v9
    s_nop 0
    v_mul_f32 v116, v116, v9
    v_mul_f32 v9, 0xbfb8aa3b, v117
    v_exp_f32 v9, v9
    s_nop 0
    v_add_f32 v9, 1.0, v9
    v_rcp_f32 v9, v9
    s_nop 0
    v_mul_f32 v117, v117, v9
    v_cvt_pk_bf16_f32 v42, v116, v117
    RND2 v118, v119, v8
    v_mul_f32 v9, 0xbfb8aa3b, v118
    v_exp_f32 v9, v9
    s_nop 0
    v_add_f32 v9, 1.0, v9
    v_rcp_f32 v9, v9
    s_nop 0
    v_mul_f32 v118, v118, v9
    v_mul_f32 v9, 0xbfb8aa3b, v119
    v_exp_f32 v9, v9
    s_nop 0
    v_add_f32 v9, 1.0, v9
    v_rcp_f32 v9, v9
    s_nop 0
    v_mul_f32 v119, v119, v9
    v_cvt_pk_bf16_f32 v43, v118, v119
    RND2 v120, v121, v8
    v_mul_f32 v9, 0xbfb8aa3b, v120
    v_exp_f32 v9, v9
    s_nop 0
    v_add_f32 v9, 1.0, v9
    v_rcp_f32 v9, v9
    s_nop 0
    v_mul_f32 v120, v120, v9
    v_mul_f32 v9, 0xbfb8aa3b, v121
    v_exp_f32 v9, v9
    s_nop 0
    v_add_f32 v9, 1.0, v9
    v_rcp_f32 v9, v9
    s_nop 0
    v_mul_f32 v121, v121, v9
    v_cvt_pk_bf16_f32 v44, v120, v121
    RND2 v122, v123, v8
    v_mul_f32 v9, 0xbfb8aa3b, v122
    v_exp_f32 v9, v9
    s_nop 0
    v_add_f32 v9, 1.0, v9
    v_rcp_f32 v9, v9
    s_nop 0
    v_mul_f32 v122, v122, v9
    v_mul_f32 v9, 0xbfb8aa3b, v123
    v_exp_f32 v9, v9
    s_nop 0
    v_add_f32 v9, 1.0, v9
    v_rcp_f32 v9, v9
    s_nop 0
    v_mul_f32 v123, v123, v9
    v_cvt_pk_bf16_f32 v45, v122, v123
    RND2 v124, v125, v8
    v_mul_f32 v9, 0xbfb8aa3b, v124
    v_exp_f32 v9, v9
    s_nop 0
    v_add_f32 v9, 1.0, v9
    v_rcp_f32 v9, v9
    s_nop 0
    v_mul_f32 v124, v124, v9
    v_mul_f32 v9, 0xbfb8aa3b, v125
    v_exp_f32 v9, v9
    s_nop 0
    v_add_f32 v9, 1.0, v9
    v_rcp_f32 v9, v9
    s_nop 0
    v_mul_f32 v125, v125, v9
    v_cvt_pk_bf16_f32 v46, v124, v125
    RND2 v126, v127, v8
    v_mul_f32 v9, 0xbfb8aa3b, v126
    v_exp_f32 v9, v9
    s_nop 0
    v_add_f32 v9, 1.0, v9
    v_rcp_f32 v9, v9
    s_nop 0
    v_mul_f32 v126, v126, v9
    v_mul_f32 v9, 0xbfb8aa3b, v127
    v_exp_f32 v9, v9
    s_nop 0
    v_add_f32 v9, 1.0, v9
    v_rcp_f32 v9, v9
    s_nop 0
    v_mul_f32 v127, v127, v9
    v_cvt_pk_bf16_f32 v47, v126, v127
    v_mul_u32_u24 v7, 768, v4
    v_lshl_add_u32 v7, v3, 3, v7
    v_add_u32 v7, 0x100000, v7
    s_nop 1
    s_mov_b32 s48, 32768
    buffer_load_dwordx4 v[128:131], v6, s[28:31], s48 offen offset:0
    buffer_load_dwordx4 v[132:135], v6, s[28:31], s48 offen offset:32
    buffer_load_dwordx4 v[136:139], v6, s[28:31], s48 offen offset:64
    buffer_load_dwordx4 v[140:143], v6, s[28:31], s48 offen offset:96
    buffer_load_dwordx4 v[144:147], v6, s[28:31], s48 offen offset:128
    buffer_load_dwordx4 v[148:151], v6, s[28:31], s48 offen offset:160
    buffer_load_dwordx4 v[152:155], v6, s[28:31], s48 offen offset:192
    buffer_load_dwordx4 v[156:159], v6, s[28:31], s48 offen offset:224
    v_mov_b32 v64, 0
    v_mov_b32 v65, 0
    v_mov_b32 v66, 0
    v_mov_b32 v67, 0
    v_mov_b32 v68, 0
    v_mov_b32 v69, 0
    v_mov_b32 v70, 0
    v_mov_b32 v71, 0
    v_mov_b32 v72, 0
    v_mov_b32 v73, 0
    v_mov_b32 v74, 0
    v_mov_b32 v75, 0
    v_mov_b32 v76, 0
    v_mov_b32 v77, 0
    v_mov_b32 v78, 0
    v_mov_b32 v79, 0
    s_waitcnt vmcnt(0)
    v_mfma_f32_32x32x16_bf16 v[64:79], v[128:131], v[16:19], v[64:79]
    v_mfma_f32_32x32x16_bf16 v[64:79], v[132:135], v[20:23], v[64:79]
    v_mfma_f32_32x32x16_bf16 v[64:79], v[136:139], v[24:27], v[64:79]
    v_mfma_f32_32x32x16_bf16 v[64:79], v[140:143], v[28:31], v[64:79]
    v_mfma_f32_32x32x16_bf16 v[64:79], v[144:147], v[32:35], v[64:79]
    v_mfma_f32_32x32x16_bf16 v[64:79], v[148:151], v[36:39], v[64:79]
    v_mfma_f32_32x32x16_bf16 v[64:79], v[152:155], v[40:43], v[64:79]
    v_mfma_f32_32x32x16_bf16 v[64:79], v[156:159], v[44:47], v[64:79]
    s_nop 15
    s_nop 7
    v_cvt_pk_bf16_f32 v80, v64, v65
    v_cvt_pk_bf16_f32 v81, v66, v67
    buffer_store_dwordx2 v[80:81], v7, s[28:31], 0 offen offset:0
    s_nop 1
    v_cvt_pk_bf16_f32 v80, v68, v69
    v_cvt_pk_bf16_f32 v81, v70, v71
    buffer_store_dwordx2 v[80:81], v7, s[28:31], 0 offen offset:16
    s_nop 1
    v_cvt_pk_bf16_f32 v80, v72, v73
    v_cvt_pk_bf16_f32 v81, v74, v75
    buffer_store_dwordx2 v[80:81], v7, s[28:31], 0 offen offset:32
    s_nop 1
    v_cvt_pk_bf16_f32 v80, v76, v77
    v_cvt_pk_bf16_f32 v81, v78, v79
    buffer_store_dwordx2 v[80:81], v7, s[28:31], 0 offen offset:48
    s_nop 1
    s_mov_b32 s48, 40960
    buffer_load_dwordx4 v[128:131], v6, s[28:31], s48 offen offset:0
    buffer_load_dwordx4 v[132:135], v6, s[28:31], s48 offen offset:32
    buffer_load_dwordx4 v[136:139], v6, s[28:31], s48 offen offset:64
    buffer_load_dwordx4 v[140:143], v6, s[28:31], s48 offen offset:96
    buffer_load_dwordx4 v[144:147], v6, s[28:31], s48 offen offset:128
    buffer_load_dwordx4 v[148:151], v6, s[28:31], s48 offen offset:160
    buffer_load_dwordx4 v[152:155], v6, s[28:31], s48 offen offset:192
    buffer_load_dwordx4 v[156:159], v6, s[28:31], s48 offen offset:224
    v_mov_b32 v64, 0
    v_mov_b32 v65, 0
    v_mov_b32 v66, 0
    v_mov_b32 v67, 0
    v_mov_b32 v68, 0
    v_mov_b32 v69, 0
    v_mov_b32 v70, 0
    v_mov_b32 v71, 0
    v_mov_b32 v72, 0
    v_mov_b32 v73, 0
    v_mov_b32 v74, 0
    v_mov_b32 v75, 0
    v_mov_b32 v76, 0
    v_mov_b32 v77, 0
    v_mov_b32 v78, 0
    v_mov_b32 v79, 0
    s_waitcnt vmcnt(0)
    v_mfma_f32_32x32x16_bf16 v[64:79], v[128:131], v[16:19], v[64:79]
    v_mfma_f32_32x32x16_bf16 v[64:79], v[132:135], v[20:23], v[64:79]
    v_mfma_f32_32x32x16_bf16 v[64:79], v[136:139], v[24:27], v[64:79]
    v_mfma_f32_32x32x16_bf16 v[64:79], v[140:143], v[28:31], v[64:79]
    v_mfma_f32_32x32x16_bf16 v[64:79], v[144:147], v[32:35], v[64:79]
    v_mfma_f32_32x32x16_bf16 v[64:79], v[148:151], v[36:39], v[64:79]
    v_mfma_f32_32x32x16_bf16 v[64:79], v[152:155], v[40:43], v[64:79]
    v_mfma_f32_32x32x16_bf16 v[64:79], v[156:159], v[44:47], v[64:79]
    s_nop 15
    s_nop 7
    v_cvt_pk_bf16_f32 v80, v64, v65
    v_cvt_pk_bf16_f32 v81, v66, v67
    buffer_store_dwordx2 v[80:81], v7, s[28:31], 0 offen offset:64
    s_nop 1
    v_cvt_pk_bf16_f32 v80, v68, v69
    v_cvt_pk_bf16_f32 v81, v70, v71
    buffer_store_dwordx2 v[80:81], v7, s[28:31], 0 offen offset:80
    s_nop 1
    v_cvt_pk_bf16_f32 v80, v72, v73
    v_cvt_pk_bf16_f32 v81, v74, v75
    buffer_store_dwordx2 v[80:81], v7, s[28:31], 0 offen offset:96
    s_nop 1
    v_cvt_pk_bf16_f32 v80, v76, v77
    v_cvt_pk_bf16_f32 v81, v78, v79
    buffer_store_dwordx2 v[80:81], v7, s[28:31], 0 offen offset:112
    s_nop 1
    s_mov_b32 s48, 49152
    buffer_load_dwordx4 v[128:131], v6, s[28:31], s48 offen offset:0
    buffer_load_dwordx4 v[132:135], v6, s[28:31], s48 offen offset:32
    buffer_load_dwordx4 v[136:139], v6, s[28:31], s48 offen offset:64
    buffer_load_dwordx4 v[140:143], v6, s[28:31], s48 offen offset:96
    buffer_load_dwordx4 v[144:147], v6, s[28:31], s48 offen offset:128
    buffer_load_dwordx4 v[148:151], v6, s[28:31], s48 offen offset:160
    buffer_load_dwordx4 v[152:155], v6, s[28:31], s48 offen offset:192
    buffer_load_dwordx4 v[156:159], v6, s[28:31], s48 offen offset:224
    v_mov_b32 v64, 0
    v_mov_b32 v65, 0
    v_mov_b32 v66, 0
    v_mov_b32 v67, 0
    v_mov_b32 v68, 0
    v_mov_b32 v69, 0
    v_mov_b32 v70, 0
    v_mov_b32 v71, 0
    v_mov_b32 v72, 0
    v_mov_b32 v73, 0
    v_mov_b32 v74, 0
    v_mov_b32 v75, 0
    v_mov_b32 v76, 0
    v_mov_b32 v77, 0
    v_mov_b32 v78, 0
    v_mov_b32 v79, 0
    s_waitcnt vmcnt(0)
    v_mfma_f32_32x32x16_bf16 v[64:79], v[128:131], v[16:19], v[64:79]
    v_mfma_f32_32x32x16_bf16 v[64:79], v[132:135], v[20:23], v[64:79]
    v_mfma_f32_32x32x16_bf16 v[64:79], v[136:139], v[24:27], v[64:79]
    v_mfma_f32_32x32x16_bf16 v[64:79], v[140:143], v[28:31], v[64:79]
    v_mfma_f32_32x32x16_bf16 v[64:79], v[144:147], v[32:35], v[64:79]
    v_mfma_f32_32x32x16_bf16 v[64:79], v[148:151], v[36:39], v[64:79]
    v_mfma_f32_32x32x16_bf16 v[64:79], v[152:155], v[40:43], v[64:79]
    v_mfma_f32_32x32x16_bf16 v[64:79], v[156:159], v[44:47], v[64:79]
    s_nop 15
    s_nop 7
    v_cvt_pk_bf16_f32 v80, v64, v65
    v_cvt_pk_bf16_f32 v81, v66, v67
    buffer_store_dwordx2 v[80:81], v7, s[28:31], 0 offen offset:128
    s_nop 1
    v_cvt_pk_bf16_f32 v80, v68, v69
    v_cvt_pk_bf16_f32 v81, v70, v71
    buffer_store_dwordx2 v[80:81], v7, s[28:31], 0 offen offset:144
    s_nop 1
    v_cvt_pk_bf16_f32 v80, v72, v73
    v_cvt_pk_bf16_f32 v81, v74, v75
    buffer_store_dwordx2 v[80:81], v7, s[28:31], 0 offen offset:160
    s_nop 1
    v_cvt_pk_bf16_f32 v80, v76, v77
    v_cvt_pk_bf16_f32 v81, v78, v79
    buffer_store_dwordx2 v[80:81], v7, s[28:31], 0 offen offset:176
    s_nop 1
    s_mov_b32 s48, 57344
    buffer_load_dwordx4 v[128:131], v6, s[28:31], s48 offen offset:0
    buffer_load_dwordx4 v[132:135], v6, s[28:31], s48 offen offset:32
    buffer_load_dwordx4 v[136:139], v6, s[28:31], s48 offen offset:64
    buffer_load_dwordx4 v[140:143], v6, s[28:31], s48 offen offset:96
    buffer_load_dwordx4 v[144:147], v6, s[28:31], s48 offen offset:128
    buffer_load_dwordx4 v[148:151], v6, s[28:31], s48 offen offset:160
    buffer_load_dwordx4 v[152:155], v6, s[28:31], s48 offen offset:192
    buffer_load_dwordx4 v[156:159], v6, s[28:31], s48 offen offset:224
    v_mov_b32 v64, 0
    v_mov_b32 v65, 0
    v_mov_b32 v66, 0
    v_mov_b32 v67, 0
    v_mov_b32 v68, 0
    v_mov_b32 v69, 0
    v_mov_b32 v70, 0
    v_mov_b32 v71, 0
    v_mov_b32 v72, 0
    v_mov_b32 v73, 0
    v_mov_b32 v74, 0
    v_mov_b32 v75, 0
    v_mov_b32 v76, 0
    v_mov_b32 v77, 0
    v_mov_b32 v78, 0
    v_mov_b32 v79, 0
    s_waitcnt vmcnt(0)
    v_mfma_f32_32x32x16_bf16 v[64:79], v[128:131], v[16:19], v[64:79]
    v_mfma_f32_32x32x16_bf16 v[64:79], v[132:135], v[20:23], v[64:79]
    v_mfma_f32_32x32x16_bf16 v[64:79], v[136:139], v[24:27], v[64:79]
    v_mfma_f32_32x32x16_bf16 v[64:79], v[140:143], v[28:31], v[64:79]
    v_mfma_f32_32x32x16_bf16 v[64:79], v[144:147], v[32:35], v[64:79]
    v_mfma_f32_32x32x16_bf16 v[64:79], v[148:151], v[36:39], v[64:79]
    v_mfma_f32_32x32x16_bf16 v[64:79], v[152:155], v[40:43], v[64:79]
    v_mfma_f32_32x32x16_bf16 v[64:79], v[156:159], v[44:47], v[64:79]
    s_nop 15
    s_nop 7
    v_cvt_pk_bf16_f32 v80, v64, v65
    v_cvt_pk_bf16_f32 v81, v66, v67
    buffer_store_dwordx2 v[80:81], v7, s[28:31], 0 offen offset:192
    s_nop 1
    v_cvt_pk_bf16_f32 v80, v68, v69
    v_cvt_pk_bf16_f32 v81, v70, v71
    buffer_store_dwordx2 v[80:81], v7, s[28:31], 0 offen offset:208
    s_nop 1
    v_cvt_pk_bf16_f32 v80, v72, v73
    v_cvt_pk_bf16_f32 v81, v74, v75
    buffer_store_dwordx2 v[80:81], v7, s[28:31], 0 offen offset:224
    s_nop 1
    v_cvt_pk_bf16_f32 v80, v76, v77
    v_cvt_pk_bf16_f32 v81, v78, v79
    buffer_store_dwordx2 v[80:81], v7, s[28:31], 0 offen offset:240
    s_nop 1
    s_mov_b32 s48, 65536
    buffer_load_dwordx4 v[128:131], v6, s[28:31], s48 offen offset:0
    buffer_load_dwordx4 v[132:135], v6, s[28:31], s48 offen offset:32
    buffer_load_dwordx4 v[136:139], v6, s[28:31], s48 offen offset:64
    buffer_load_dwordx4 v[140:143], v6, s[28:31], s48 offen offset:96
    buffer_load_dwordx4 v[144:147], v6, s[28:31], s48 offen offset:128
    buffer_load_dwordx4 v[148:151], v6, s[28:31], s48 offen offset:160
    buffer_load_dwordx4 v[152:155], v6, s[28:31], s48 offen offset:192
    buffer_load_dwordx4 v[156:159], v6, s[28:31], s48 offen offset:224
    v_mov_b32 v64, 0
    v_mov_b32 v65, 0
    v_mov_b32 v66, 0
    v_mov_b32 v67, 0
    v_mov_b32 v68, 0
    v_mov_b32 v69, 0
    v_mov_b32 v70, 0
    v_mov_b32 v71, 0
    v_mov_b32 v72, 0
    v_mov_b32 v73, 0
    v_mov_b32 v74, 0
    v_mov_b32 v75, 0
    v_mov_b32 v76, 0
    v_mov_b32 v77, 0
    v_mov_b32 v78, 0
    v_mov_b32 v79, 0
    s_waitcnt vmcnt(0)
    v_mfma_f32_32x32x16_bf16 v[64:79], v[128:131], v[16:19], v[64:79]
    v_mfma_f32_32x32x16_bf16 v[64:79], v[132:135], v[20:23], v[64:79]
    v_mfma_f32_32x32x16_bf16 v[64:79], v[136:139], v[24:27], v[64:79]
    v_mfma_f32_32x32x16_bf16 v[64:79], v[140:143], v[28:31], v[64:79]
    v_mfma_f32_32x32x16_bf16 v[64:79], v[144:147], v[32:35], v[64:79]
    v_mfma_f32_32x32x16_bf16 v[64:79], v[148:151], v[36:39], v[64:79]
    v_mfma_f32_32x32x16_bf16 v[64:79], v[152:155], v[40:43], v[64:79]
    v_mfma_f32_32x32x16_bf16 v[64:79], v[156:159], v[44:47], v[64:79]
    s_nop 15
    s_nop 7
    v_cvt_pk_bf16_f32 v80, v64, v65
    v_cvt_pk_bf16_f32 v81, v66, v67
    buffer_store_dwordx2 v[80:81], v7, s[28:31], 0 offen offset:256
    s_nop 1
    v_cvt_pk_bf16_f32 v80, v68, v69
    v_cvt_pk_bf16_f32 v81, v70, v71
    buffer_store_dwordx2 v[80:81], v7, s[28:31], 0 offen offset:272
    s_nop 1
    v_cvt_pk_bf16_f32 v80, v72, v73
    v_cvt_pk_bf16_f32 v81, v74, v75
    buffer_store_dwordx2 v[80:81], v7, s[28:31], 0 offen offset:288
    s_nop 1
    v_cvt_pk_bf16_f32 v80, v76, v77
    v_cvt_pk_bf16_f32 v81, v78, v79
    buffer_store_dwordx2 v[80:81], v7, s[28:31], 0 offen offset:304
    s_nop 1
    s_mov_b32 s48, 73728
    buffer_load_dwordx4 v[128:131], v6, s[28:31], s48 offen offset:0
    buffer_load_dwordx4 v[132:135], v6, s[28:31], s48 offen offset:32
    buffer_load_dwordx4 v[136:139], v6, s[28:31], s48 offen offset:64
    buffer_load_dwordx4 v[140:143], v6, s[28:31], s48 offen offset:96
    buffer_load_dwordx4 v[144:147], v6, s[28:31], s48 offen offset:128
    buffer_load_dwordx4 v[148:151], v6, s[28:31], s48 offen offset:160
    buffer_load_dwordx4 v[152:155], v6, s[28:31], s48 offen offset:192
    buffer_load_dwordx4 v[156:159], v6, s[28:31], s48 offen offset:224
    v_mov_b32 v64, 0
    v_mov_b32 v65, 0
    v_mov_b32 v66, 0
    v_mov_b32 v67, 0
    v_mov_b32 v68, 0
    v_mov_b32 v69, 0
    v_mov_b32 v70, 0
    v_mov_b32 v71, 0
    v_mov_b32 v72, 0
    v_mov_b32 v73, 0
    v_mov_b32 v74, 0
    v_mov_b32 v75, 0
    v_mov_b32 v76, 0
    v_mov_b32 v77, 0
    v_mov_b32 v78, 0
    v_mov_b32 v79, 0
    s_waitcnt vmcnt(0)
    v_mfma_f32_32x32x16_bf16 v[64:79], v[128:131], v[16:19], v[64:79]
    v_mfma_f32_32x32x16_bf16 v[64:79], v[132:135], v[20:23], v[64:79]
    v_mfma_f32_32x32x16_bf16 v[64:79], v[136:139], v[24:27], v[64:79]
    v_mfma_f32_32x32x16_bf16 v[64:79], v[140:143], v[28:31], v[64:79]
    v_mfma_f32_32x32x16_bf16 v[64:79], v[144:147], v[32:35], v[64:79]
    v_mfma_f32_32x32x16_bf16 v[64:79], v[148:151], v[36:39], v[64:79]
    v_mfma_f32_32x32x16_bf16 v[64:79], v[152:155], v[40:43], v[64:79]
    v_mfma_f32_32x32x16_bf16 v[64:79], v[156:159], v[44:47], v[64:79]
    s_nop 15
    s_nop 7
    v_cvt_pk_bf16_f32 v80, v64, v65
    v_cvt_pk_bf16_f32 v81, v66, v67
    buffer_store_dwordx2 v[80:81], v7, s[28:31], 0 offen offset:320
    s_nop 1
    v_cvt_pk_bf16_f32 v80, v68, v69
    v_cvt_pk_bf16_f32 v81, v70, v71
    buffer_store_dwordx2 v[80:81], v7, s[28:31], 0 offen offset:336
    s_nop 1
    v_cvt_pk_bf16_f32 v80, v72, v73
    v_cvt_pk_bf16_f32 v81, v74, v75
    buffer_store_dwordx2 v[80:81], v7, s[28:31], 0 offen offset:352
    s_nop 1
    v_cvt_pk_bf16_f32 v80, v76, v77
    v_cvt_pk_bf16_f32 v81, v78, v79
    buffer_store_dwordx2 v[80:81], v7, s[28:31], 0 offen offset:368
    s_nop 1
    s_mov_b32 s48, 81920
    buffer_load_dwordx4 v[128:131], v6, s[28:31], s48 offen offset:0
    buffer_load_dwordx4 v[132:135], v6, s[28:31], s48 offen offset:32
    buffer_load_dwordx4 v[136:139], v6, s[28:31], s48 offen offset:64
    buffer_load_dwordx4 v[140:143], v6, s[28:31], s48 offen offset:96
    buffer_load_dwordx4 v[144:147], v6, s[28:31], s48 offen offset:128
    buffer_load_dwordx4 v[148:151], v6, s[28:31], s48 offen offset:160
    buffer_load_dwordx4 v[152:155], v6, s[28:31], s48 offen offset:192
    buffer_load_dwordx4 v[156:159], v6, s[28:31], s48 offen offset:224
    v_mov_b32 v64, 0
    v_mov_b32 v65, 0
    v_mov_b32 v66, 0
    v_mov_b32 v67, 0
    v_mov_b32 v68, 0
    v_mov_b32 v69, 0
    v_mov_b32 v70, 0
    v_mov_b32 v71, 0
    v_mov_b32 v72, 0
    v_mov_b32 v73, 0
    v_mov_b32 v74, 0
    v_mov_b32 v75, 0
    v_mov_b32 v76, 0
    v_mov_b32 v77, 0
    v_mov_b32 v78, 0
    v_mov_b32 v79, 0
    s_waitcnt vmcnt(0)
    v_mfma_f32_32x32x16_bf16 v[64:79], v[128:131], v[16:19], v[64:79]
    v_mfma_f32_32x32x16_bf16 v[64:79], v[132:135], v[20:23], v[64:79]
    v_mfma_f32_32x32x16_bf16 v[64:79], v[136:139], v[24:27], v[64:79]
    v_mfma_f32_32x32x16_bf16 v[64:79], v[140:143], v[28:31], v[64:79]
    v_mfma_f32_32x32x16_bf16 v[64:79], v[144:147], v[32:35], v[64:79]
    v_mfma_f32_32x32x16_bf16 v[64:79], v[148:151], v[36:39], v[64:79]
    v_mfma_f32_32x32x16_bf16 v[64:79], v[152:155], v[40:43], v[64:79]
    v_mfma_f32_32x32x16_bf16 v[64:79], v[156:159], v[44:47], v[64:79]
    s_nop 15
    s_nop 7
    v_cvt_pk_bf16_f32 v80, v64, v65
    v_cvt_pk_bf16_f32 v81, v66, v67
    buffer_store_dwordx2 v[80:81], v7, s[28:31], 0 offen offset:384
    s_nop 1
    v_cvt_pk_bf16_f32 v80, v68, v69
    v_cvt_pk_bf16_f32 v81, v70, v71
    buffer_store_dwordx2 v[80:81], v7, s[28:31], 0 offen offset:400
    s_nop 1
    v_cvt_pk_bf16_f32 v80, v72, v73
    v_cvt_pk_bf16_f32 v81, v74, v75
    buffer_store_dwordx2 v[80:81], v7, s[28:31], 0 offen offset:416
    s_nop 1
    v_cvt_pk_bf16_f32 v80, v76, v77
    v_cvt_pk_bf16_f32 v81, v78, v79
    buffer_store_dwordx2 v[80:81], v7, s[28:31], 0 offen offset:432
    s_nop 1
    s_mov_b32 s48, 90112
    buffer_load_dwordx4 v[128:131], v6, s[28:31], s48 offen offset:0
    buffer_load_dwordx4 v[132:135], v6, s[28:31], s48 offen offset:32
    buffer_load_dwordx4 v[136:139], v6, s[28:31], s48 offen offset:64
    buffer_load_dwordx4 v[140:143], v6, s[28:31], s48 offen offset:96
    buffer_load_dwordx4 v[144:147], v6, s[28:31], s48 offen offset:128
    buffer_load_dwordx4 v[148:151], v6, s[28:31], s48 offen offset:160
    buffer_load_dwordx4 v[152:155], v6, s[28:31], s48 offen offset:192
    buffer_load_dwordx4 v[156:159], v6, s[28:31], s48 offen offset:224
    v_mov_b32 v64, 0
    v_mov_b32 v65, 0
    v_mov_b32 v66, 0
    v_mov_b32 v67, 0
    v_mov_b32 v68, 0
    v_mov_b32 v69, 0
    v_mov_b32 v70, 0
    v_mov_b32 v71, 0
    v_mov_b32 v72, 0
    v_mov_b32 v73, 0
    v_mov_b32 v74, 0
    v_mov_b32 v75, 0
    v_mov_b32 v76, 0
    v_mov_b32 v77, 0
    v_mov_b32 v78, 0
    v_mov_b32 v79, 0
    s_waitcnt vmcnt(0)
    v_mfma_f32_32x32x16_bf16 v[64:79], v[128:131], v[16:19], v[64:79]
    v_mfma_f32_32x32x16_bf16 v[64:79], v[132:135], v[20:23], v[64:79]
    v_mfma_f32_32x32x16_bf16 v[64:79], v[136:139], v[24:27], v[64:79]
    v_mfma_f32_32x32x16_bf16 v[64:79], v[140:143], v[28:31], v[64:79]
    v_mfma_f32_32x32x16_bf16 v[64:79], v[144:147], v[32:35], v[64:79]
    v_mfma_f32_32x32x16_bf16 v[64:79], v[148:151], v[36:39], v[64:79]
    v_mfma_f32_32x32x16_bf16 v[64:79], v[152:155], v[40:43], v[64:79]
    v_mfma_f32_32x32x16_bf16 v[64:79], v[156:159], v[44:47], v[64:79]
    s_nop 15
    s_nop 7
    v_cvt_pk_bf16_f32 v80, v64, v65
    v_cvt_pk_bf16_f32 v81, v66, v67
    buffer_store_dwordx2 v[80:81], v7, s[28:31], 0 offen offset:448
    s_nop 1
    v_cvt_pk_bf16_f32 v80, v68, v69
    v_cvt_pk_bf16_f32 v81, v70, v71
    buffer_store_dwordx2 v[80:81], v7, s[28:31], 0 offen offset:464
    s_nop 1
    v_cvt_pk_bf16_f32 v80, v72, v73
    v_cvt_pk_bf16_f32 v81, v74, v75
    buffer_store_dwordx2 v[80:81], v7, s[28:31], 0 offen offset:480
    s_nop 1
    v_cvt_pk_bf16_f32 v80, v76, v77
    v_cvt_pk_bf16_f32 v81, v78, v79
    buffer_store_dwordx2 v[80:81], v7, s[28:31], 0 offen offset:496
    s_nop 1
    s_mov_b32 s48, 98304
    buffer_load_dwordx4 v[128:131], v6, s[28:31], s48 offen offset:0
    buffer_load_dwordx4 v[132:135], v6, s[28:31], s48 offen offset:32
    buffer_load_dwordx4 v[136:139], v6, s[28:31], s48 offen offset:64
    buffer_load_dwordx4 v[140:143], v6, s[28:31], s48 offen offset:96
    buffer_load_dwordx4 v[144:147], v6, s[28:31], s48 offen offset:128
    buffer_load_dwordx4 v[148:151], v6, s[28:31], s48 offen offset:160
    buffer_load_dwordx4 v[152:155], v6, s[28:31], s48 offen offset:192
    buffer_load_dwordx4 v[156:159], v6, s[28:31], s48 offen offset:224
    v_mov_b32 v64, 0
    v_mov_b32 v65, 0
    v_mov_b32 v66, 0
    v_mov_b32 v67, 0
    v_mov_b32 v68, 0
    v_mov_b32 v69, 0
    v_mov_b32 v70, 0
    v_mov_b32 v71, 0
    v_mov_b32 v72, 0
    v_mov_b32 v73, 0
    v_mov_b32 v74, 0
    v_mov_b32 v75, 0
    v_mov_b32 v76, 0
    v_mov_b32 v77, 0
    v_mov_b32 v78, 0
    v_mov_b32 v79, 0
    s_waitcnt vmcnt(0)
    v_mfma_f32_32x32x16_bf16 v[64:79], v[128:131], v[16:19], v[64:79]
    v_mfma_f32_32x32x16_bf16 v[64:79], v[132:135], v[20:23], v[64:79]
    v_mfma_f32_32x32x16_bf16 v[64:79], v[136:139], v[24:27], v[64:79]
    v_mfma_f32_32x32x16_bf16 v[64:79], v[140:143], v[28:31], v[64:79]
    v_mfma_f32_32x32x16_bf16 v[64:79], v[144:147], v[32:35], v[64:79]
    v_mfma_f32_32x32x16_bf16 v[64:79], v[148:151], v[36:39], v[64:79]
    v_mfma_f32_32x32x16_bf16 v[64:79], v[152:155], v[40:43], v[64:79]
    v_mfma_f32_32x32x16_bf16 v[64:79], v[156:159], v[44:47], v[64:79]
    s_nop 15
    s_nop 7
    v_cvt_pk_bf16_f32 v80, v64, v65
    v_cvt_pk_bf16_f32 v81, v66, v67
    buffer_store_dwordx2 v[80:81], v7, s[28:31], 0 offen offset:512
    s_nop 1
    v_cvt_pk_bf16_f32 v80, v68, v69
    v_cvt_pk_bf16_f32 v81, v70, v71
    buffer_store_dwordx2 v[80:81], v7, s[28:31], 0 offen offset:528
    s_nop 1
    v_cvt_pk_bf16_f32 v80, v72, v73
    v_cvt_pk_bf16_f32 v81, v74, v75
    buffer_store_dwordx2 v[80:81], v7, s[28:31], 0 offen offset:544
    s_nop 1
    v_cvt_pk_bf16_f32 v80, v76, v77
    v_cvt_pk_bf16_f32 v81, v78, v79
    buffer_store_dwordx2 v[80:81], v7, s[28:31], 0 offen offset:560
    s_nop 1
    s_mov_b32 s48, 106496
    buffer_load_dwordx4 v[128:131], v6, s[28:31], s48 offen offset:0
    buffer_load_dwordx4 v[132:135], v6, s[28:31], s48 offen offset:32
    buffer_load_dwordx4 v[136:139], v6, s[28:31], s48 offen offset:64
    buffer_load_dwordx4 v[140:143], v6, s[28:31], s48 offen offset:96
    buffer_load_dwordx4 v[144:147], v6, s[28:31], s48 offen offset:128
    buffer_load_dwordx4 v[148:151], v6, s[28:31], s48 offen offset:160
    buffer_load_dwordx4 v[152:155], v6, s[28:31], s48 offen offset:192
    buffer_load_dwordx4 v[156:159], v6, s[28:31], s48 offen offset:224
    v_mov_b32 v64, 0
    v_mov_b32 v65, 0
    v_mov_b32 v66, 0
    v_mov_b32 v67, 0
    v_mov_b32 v68, 0
    v_mov_b32 v69, 0
    v_mov_b32 v70, 0
    v_mov_b32 v71, 0
    v_mov_b32 v72, 0
    v_mov_b32 v73, 0
    v_mov_b32 v74, 0
    v_mov_b32 v75, 0
    v_mov_b32 v76, 0
    v_mov_b32 v77, 0
    v_mov_b32 v78, 0
    v_mov_b32 v79, 0
    s_waitcnt vmcnt(0)
    v_mfma_f32_32x32x16_bf16 v[64:79], v[128:131], v[16:19], v[64:79]
    v_mfma_f32_32x32x16_bf16 v[64:79], v[132:135], v[20:23], v[64:79]
    v_mfma_f32_32x32x16_bf16 v[64:79], v[136:139], v[24:27], v[64:79]
    v_mfma_f32_32x32x16_bf16 v[64:79], v[140:143], v[28:31], v[64:79]
    v_mfma_f32_32x32x16_bf16 v[64:79], v[144:147], v[32:35], v[64:79]
    v_mfma_f32_32x32x16_bf16 v[64:79], v[148:151], v[36:39], v[64:79]
    v_mfma_f32_32x32x16_bf16 v[64:79], v[152:155], v[40:43], v[64:79]
    v_mfma_f32_32x32x16_bf16 v[64:79], v[156:159], v[44:47], v[64:79]
    s_nop 15
    s_nop 7
    v_cvt_pk_bf16_f32 v80, v64, v65
    v_cvt_pk_bf16_f32 v81, v66, v67
    buffer_store_dwordx2 v[80:81], v7, s[28:31], 0 offen offset:576
    s_nop 1
    v_cvt_pk_bf16_f32 v80, v68, v69
    v_cvt_pk_bf16_f32 v81, v70, v71
    buffer_store_dwordx2 v[80:81], v7, s[28:31], 0 offen offset:592
    s_nop 1
    v_cvt_pk_bf16_f32 v80, v72, v73
    v_cvt_pk_bf16_f32 v81, v74, v75
    buffer_store_dwordx2 v[80:81], v7, s[28:31], 0 offen offset:608
    s_nop 1
    v_cvt_pk_bf16_f32 v80, v76, v77
    v_cvt_pk_bf16_f32 v81, v78, v79
    buffer_store_dwordx2 v[80:81], v7, s[28:31], 0 offen offset:624
    s_nop 1
    s_mov_b32 s48, 114688
    buffer_load_dwordx4 v[128:131], v6, s[28:31], s48 offen offset:0
    buffer_load_dwordx4 v[132:135], v6, s[28:31], s48 offen offset:32
    buffer_load_dwordx4 v[136:139], v6, s[28:31], s48 offen offset:64
    buffer_load_dwordx4 v[140:143], v6, s[28:31], s48 offen offset:96
    buffer_load_dwordx4 v[144:147], v6, s[28:31], s48 offen offset:128
    buffer_load_dwordx4 v[148:151], v6, s[28:31], s48 offen offset:160
    buffer_load_dwordx4 v[152:155], v6, s[28:31], s48 offen offset:192
    buffer_load_dwordx4 v[156:159], v6, s[28:31], s48 offen offset:224
    v_mov_b32 v64, 0
    v_mov_b32 v65, 0
    v_mov_b32 v66, 0
    v_mov_b32 v67, 0
    v_mov_b32 v68, 0
    v_mov_b32 v69, 0
    v_mov_b32 v70, 0
    v_mov_b32 v71, 0
    v_mov_b32 v72, 0
    v_mov_b32 v73, 0
    v_mov_b32 v74, 0
    v_mov_b32 v75, 0
    v_mov_b32 v76, 0
    v_mov_b32 v77, 0
    v_mov_b32 v78, 0
    v_mov_b32 v79, 0
    s_waitcnt vmcnt(0)
    v_mfma_f32_32x32x16_bf16 v[64:79], v[128:131], v[16:19], v[64:79]
    v_mfma_f32_32x32x16_bf16 v[64:79], v[132:135], v[20:23], v[64:79]
    v_mfma_f32_32x32x16_bf16 v[64:79], v[136:139], v[24:27], v[64:79]
    v_mfma_f32_32x32x16_bf16 v[64:79], v[140:143], v[28:31], v[64:79]
    v_mfma_f32_32x32x16_bf16 v[64:79], v[144:147], v[32:35], v[64:79]
    v_mfma_f32_32x32x16_bf16 v[64:79], v[148:151], v[36:39], v[64:79]
    v_mfma_f32_32x32x16_bf16 v[64:79], v[152:155], v[40:43], v[64:79]
    v_mfma_f32_32x32x16_bf16 v[64:79], v[156:159], v[44:47], v[64:79]
    s_nop 15
    s_nop 7
    v_cvt_pk_bf16_f32 v80, v64, v65
    v_cvt_pk_bf16_f32 v81, v66, v67
    buffer_store_dwordx2 v[80:81], v7, s[28:31], 0 offen offset:640
    s_nop 1
    v_cvt_pk_bf16_f32 v80, v68, v69
    v_cvt_pk_bf16_f32 v81, v70, v71
    buffer_store_dwordx2 v[80:81], v7, s[28:31], 0 offen offset:656
    s_nop 1
    v_cvt_pk_bf16_f32 v80, v72, v73
    v_cvt_pk_bf16_f32 v81, v74, v75
    buffer_store_dwordx2 v[80:81], v7, s[28:31], 0 offen offset:672
    s_nop 1
    v_cvt_pk_bf16_f32 v80, v76, v77
    v_cvt_pk_bf16_f32 v81, v78, v79
    buffer_store_dwordx2 v[80:81], v7, s[28:31], 0 offen offset:688
    s_nop 1
    s_mov_b32 s48, 122880
    buffer_load_dwordx4 v[128:131], v6, s[28:31], s48 offen offset:0
    buffer_load_dwordx4 v[132:135], v6, s[28:31], s48 offen offset:32
    buffer_load_dwordx4 v[136:139], v6, s[28:31], s48 offen offset:64
    buffer_load_dwordx4 v[140:143], v6, s[28:31], s48 offen offset:96
    buffer_load_dwordx4 v[144:147], v6, s[28:31], s48 offen offset:128
    buffer_load_dwordx4 v[148:151], v6, s[28:31], s48 offen offset:160
    buffer_load_dwordx4 v[152:155], v6, s[28:31], s48 offen offset:192
    buffer_load_dwordx4 v[156:159], v6, s[28:31], s48 offen offset:224
    v_mov_b32 v64, 0
    v_mov_b32 v65, 0
    v_mov_b32 v66, 0
    v_mov_b32 v67, 0
    v_mov_b32 v68, 0
    v_mov_b32 v69, 0
    v_mov_b32 v70, 0
    v_mov_b32 v71, 0
    v_mov_b32 v72, 0
    v_mov_b32 v73, 0
    v_mov_b32 v74, 0
    v_mov_b32 v75, 0
    v_mov_b32 v76, 0
    v_mov_b32 v77, 0
    v_mov_b32 v78, 0
    v_mov_b32 v79, 0
    s_waitcnt vmcnt(0)
    v_mfma_f32_32x32x16_bf16 v[64:79], v[128:131], v[16:19], v[64:79]
    v_mfma_f32_32x32x16_bf16 v[64:79], v[132:135], v[20:23], v[64:79]
    v_mfma_f32_32x32x16_bf16 v[64:79], v[136:139], v[24:27], v[64:79]
    v_mfma_f32_32x32x16_bf16 v[64:79], v[140:143], v[28:31], v[64:79]
    v_mfma_f32_32x32x16_bf16 v[64:79], v[144:147], v[32:35], v[64:79]
    v_mfma_f32_32x32x16_bf16 v[64:79], v[148:151], v[36:39], v[64:79]
    v_mfma_f32_32x32x16_bf16 v[64:79], v[152:155], v[40:43], v[64:79]
    v_mfma_f32_32x32x16_bf16 v[64:79], v[156:159], v[44:47], v[64:79]
    s_nop 15
    s_nop 7
    v_cvt_pk_bf16_f32 v80, v64, v65
    v_cvt_pk_bf16_f32 v81, v66, v67
    buffer_store_dwordx2 v[80:81], v7, s[28:31], 0 offen offset:704
    s_nop 1
    v_cvt_pk_bf16_f32 v80, v68, v69
    v_cvt_pk_bf16_f32 v81, v70, v71
    buffer_store_dwordx2 v[80:81], v7, s[28:31], 0 offen offset:720
    s_nop 1
    v_cvt_pk_bf16_f32 v80, v72, v73
    v_cvt_pk_bf16_f32 v81, v74, v75
    buffer_store_dwordx2 v[80:81], v7, s[28:31], 0 offen offset:736
    s_nop 1
    v_cvt_pk_bf16_f32 v80, v76, v77
    v_cvt_pk_bf16_f32 v81, v78, v79
    buffer_store_dwordx2 v[80:81], v7, s[28:31], 0 offen offset:752
    s_nop 1
    s_endpgm
k1_edges:
    s_sub_u32 s3, s2, 196
    s_lshl_b32 s3, s3, 8
    v_add_u32 v1, s3, v0
    s_mov_b32 s49, 400000
    v_cmp_gt_u32 vcc, s49, v1
    s_and_saveexec_b64 s[50:51], vcc
    s_cbranch_execz k1_end
    v_lshlrev_b32 v2, 2, v1
    buffer_load_dword v3, v2, s[20:23], 0 offen
    buffer_load_dword v4, v2, s[24:27], 0 offen
    s_waitcnt vmcnt(0)
    v_mul_u32_u24 v5, 6, v3
    v_mul_u32_u24 v6, 6, v4
    buffer_load_ushort v8, v5, s[16:19], 0 offen
    buffer_load_ushort v9, v5, s[16:19], 0 offen offset:2
    buffer_load_ushort v10, v5, s[16:19], 0 offen offset:4
    buffer_load_ushort v11, v6, s[16:19], 0 offen
    buffer_load_ushort v12, v6, s[16:19], 0 offen offset:2
    buffer_load_ushort v13, v6, s[16:19], 0 offen offset:4
    s_waitcnt vmcnt(0)
    v_lshlrev_b32 v8, 16, v8
    v_lshlrev_b32 v9, 16, v9
    v_lshlrev_b32 v10, 16, v10
    v_lshlrev_b32 v11, 16, v11
    v_lshlrev_b32 v12, 16, v12
    v_lshlrev_b32 v13, 16, v13
    v_sub_f32 v8, v8, v11
    v_sub_f32 v9, v9, v12
    v_sub_f32 v10, v10, v13
    RND2 v8, v9, v14
    RND2 v10, v11, v14
    v_mul_f32 v12, v8, v8
    v_mul_f32 v13, v9, v9
    v_mul_f32 v15, v10, v10
    RND2 v12, v13, v14
    RND2 v15, v16, v14
    v_add_f32 v12, v12, v13
    v_add_f32 v12, v12, v15
    RND2 v12, v13, v14
    v_add_f32 v12, 0x322bcc77, v12
    RND2 v12, v13, v14
    v_sqrt_f32 v12, v12
    s_nop 0
    RND2 v12, v13, v14
    v_cmp_gt_f32 vcc, 0x40a00000, v12
    s_and_saveexec_b64 s[52:53], vcc
    s_cbranch_execz k1_end
    v_rcp_f32 v13, v12
    s_nop 0
    v_mul_f32 v18, v8, v13
    v_mul_f32 v19, v9, v13
    v_mul_f32 v20, v10, v13
    RND2 v18, v19, v14
    RND2 v20, v21, v14
    v_mul_f32 v21, 0x40490fdb, v12
    RND2 v21, v22, v14
    v_mul_f32 v21, 0x3e4ccccd, v21
    RND2 v21, v22, v14
    v_mul_f32 v21, 0.15915494, v21
    v_fract_f32 v21, v21
    v_cos_f32 v21, v21
    s_nop 0
    RND2 v21, v22, v14
    v_add_f32 v21, 1.0, v21
    RND2 v21, v22, v14
    v_mul_f32 v21, 0.5, v21
    s_waitcnt lgkmcnt(0)
    s_lshl_b32 s54, s40, 16
    s_and_b32 s55, s40, 0xffff0000
    v_mul_f32 v32, s54, v12
    v_mul_f32 v33, s55, v12
    RND2 v32, v33, v14
    v_mul_f32 v32, 0.15915494, v32
    v_mul_f32 v33, 0.15915494, v33
    v_fract_f32 v32, v32
    v_fract_f32 v33, v33
    v_sin_f32 v32, v32
    v_sin_f32 v33, v33
    s_nop 0
    RND2 v32, v33, v14
    v_mul_f32 v32, v32, v13
    v_mul_f32 v33, v33, v13
    v_cvt_pk_bf16_f32 v24, v32, v33
    s_lshl_b32 s54, s41, 16
    s_and_b32 s55, s41, 0xffff0000
    v_mul_f32 v32, s54, v12
    v_mul_f32 v33, s55, v12
    RND2 v32, v33, v14
    v_mul_f32 v32, 0.15915494, v32
    v_mul_f32 v33, 0.15915494, v33
    v_fract_f32 v32, v32
    v_fract_f32 v33, v33
    v_sin_f32 v32, v32
    v_sin_f32 v33, v33
    s_nop 0
    RND2 v32, v33, v14
    v_mul_f32 v32, v32, v13
    v_mul_f32 v33, v33, v13
    v_cvt_pk_bf16_f32 v25, v32, v33
    s_lshl_b32 s54, s42, 16
    s_and_b32 s55, s42, 0xffff0000
    v_mul_f32 v32, s54, v12
    v_mul_f32 v33, s55, v12
    RND2 v32, v33, v14
    v_mul_f32 v32, 0.15915494, v32
    v_mul_f32 v33, 0.15915494, v33
    v_fract_f32 v32, v32
    v_fract_f32 v33, v33
    v_sin_f32 v32, v32
    v_sin_f32 v33, v33
    s_nop 0
    RND2 v32, v33, v14
    v_mul_f32 v32, v32, v13
    v_mul_f32 v33, v33, v13
    v_cvt_pk_bf16_f32 v26, v32, v33
    s_lshl_b32 s54, s43, 16
    s_and_b32 s55, s43, 0xffff0000
    v_mul_f32 v32, s54, v12
    v_mul_f32 v33, s55, v12
    RND2 v32, v33, v14
    v_mul_f32 v32, 0.15915494, v32
    v_mul_f32 v33, 0.15915494, v33
    v_fract_f32 v32, v32
    v_fract_f32 v33, v33
    v_sin_f32 v32, v32
    v_sin_f32 v33, v33
    s_nop 0
    RND2 v32, v33, v14
    v_mul_f32 v32, v32, v13
    v_mul_f32 v33, v33, v13
    v_cvt_pk_bf16_f32 v27, v32, v33
    s_lshl_b32 s54, s44, 16
    s_and_b32 s55, s44, 0xffff0000
    v_mul_f32 v32, s54, v12
    v_mul_f32 v33, s55, v12
    RND2 v32, v33, v14
    v_mul_f32 v32, 0.15915494, v32
    v_mul_f32 v33, 0.15915494, v33
    v_fract_f32 v32, v32
    v_fract_f32 v33, v33
    v_sin_f32 v32, v32
    v_sin_f32 v33, v33
    s_nop 0
    RND2 v32, v33, v14
    v_mul_f32 v32, v32, v13
    v_mul_f32 v33, v33, v13
    v_cvt_pk_bf16_f32 v28, v32, v33
    s_lshl_b32 s54, s45, 16
    s_and_b32 s55, s45, 0xffff0000
    v_mul_f32 v32, s54, v12
    v_mul_f32 v33, s55, v12
    RND2 v32, v33, v14
    v_mul_f32 v32, 0.15915494, v32
    v_mul_f32 v33, 0.15915494, v33
    v_fract_f32 v32, v32
    v_fract_f32 v33, v33
    v_sin_f32 v32, v32
    v_sin_f32 v33, v33
    s_nop 0
    RND2 v32, v33, v14
    v_mul_f32 v32, v32, v13
    v_mul_f32 v33, v33, v13
    v_cvt_pk_bf16_f32 v29, v32, v33
    s_lshl_b32 s54, s46, 16
    s_and_b32 s55, s46, 0xffff0000
    v_mul_f32 v32, s54, v12
    v_mul_f32 v33, s55, v12
    RND2 v32, v33, v14
    v_mul_f32 v32, 0.15915494, v32
    v_mul_f32 v33, 0.15915494, v33
    v_fract_f32 v32, v32
    v_fract_f32 v33, v33
    v_sin_f32 v32, v32
    v_sin_f32 v33, v33
    s_nop 0
    RND2 v32, v33, v14
    v_mul_f32 v32, v32, v13
    v_mul_f32 v33, v33, v13
    v_cvt_pk_bf16_f32 v30, v32, v33
    s_lshl_b32 s54, s47, 16
    s_and_b32 s55, s47, 0xffff0000
    v_mul_f32 v32, s54, v12
    v_mul_f32 v33, s55, v12
    RND2 v32, v33, v14
    v_mul_f32 v32, 0.15915494, v32
    v_mul_f32 v33, 0.15915494, v33
    v_fract_f32 v32, v32
    v_fract_f32 v33, v33
    v_sin_f32 v32, v32
    v_sin_f32 v33, v33
    s_nop 0
    RND2 v32, v33, v14
    v_mul_f32 v32, v32, v13
    v_mul_f32 v33, v33, v13
    v_cvt_pk_bf16_f32 v31, v32, v33
    v_mov_b32 v17, v1
    v_lshlrev_b32 v6, 2, v4
    buffer_atomic_swap v17, v6, s[28:31], 0 offen sc0
    v_mov_b32 v16, v3
    v_lshlrev_b32 v7, 6, v1
    v_add_u32 v7, 0x2000000, v7
    v_mov_b32 v22, 0
    v_mov_b32 v23, 0
    s_waitcnt vmcnt(0)
    buffer_store_dwordx4 v[16:19], v7, s[28:31], 0 offen
    buffer_store_dwordx4 v[20:23], v7, s[28:31], 0 offen offset:16
    buffer_store_dwordx4 v[24:27], v7, s[28:31], 0 offen offset:32
    buffer_store_dwordx4 v[28:31], v7, s[28:31], 0 offen offset:48
k1_end:
    s_endpgm
.globl standalone__molecular_angular_painn__graph_kernel
.p2align 8
.type standalone__molecular_angular_painn__graph_kernel,@function
standalone__molecular_angular_painn__graph_kernel:
    s_cmp_ge_u32 s2, 6250
    s_cbranch_scc1 k2_end
    s_load_dwordx2 s[4:5], s[0:1], 0
    s_load_dwordx2 s[6:7], s[0:1], 64
    s_load_dwordx2 s[8:9], s[0:1], 80
    v_lshrrev_b32 v1, 6, v0
    s_nop 0
    v_readfirstlane_b32 s3, v1
    s_lshl_b32 s10, s2, 2
    s_add_u32 s3, s3, s10
    s_lshl_b32 s10, s3, 2
    s_waitcnt lgkmcnt(0)
    s_add_u32 s36, s8, s10
    s_addc_u32 s37, s9, 0
    s_load_dword s34, s[36:37], 0
    SRD 12, 4, 0, 25600000
    SRD 16, 6, 0, 25600000
    SRD 20, 8, 0, 0x10000000
    SRD 24, 8, 0x100000, 0x1f00000
    s_add_u32 s38, s8, 0x2000000
    s_addc_u32 s39, s9, 0
    v_and_b32 v1, 63, v0
    v_lshlrev_b32 v1, 2, v1
    s_lshl_b32 s11, s3, 10
    buffer_load_dword v2, v1, s[12:15], s11 offen offset:0
    buffer_load_dword v3, v1, s[12:15], s11 offen offset:256
    buffer_load_dword v4, v1, s[12:15], s11 offen offset:512
    buffer_load_dword v5, v1, s[12:15], s11 offen offset:768
    v_mov_b32 v8, 0
    v_mov_b32 v9, 0
    v_mov_b32 v10, 0
    v_mov_b32 v11, 0
    v_mov_b32 v12, 0
    v_mov_b32 v13, 0
    v_mov_b32 v14, 0
    v_mov_b32 v15, 0
    s_waitcnt lgkmcnt(0)
    s_cmp_eq_u32 s34, -1
    s_cbranch_scc1 k2_fin
    v_lshlrev_b32 v6, 1, v1
    v_add_u32 v6, 0x40000, v6
    s_mov_b32 s62, 0
    buffer_load_dwordx2 v[64:65], v6, s[20:23], s62 offen offset:0
    s_mov_b32 s62, 0
    buffer_load_dwordx2 v[66:67], v6, s[20:23], s62 offen offset:512
    s_mov_b32 s62, 0
    buffer_load_dwordx2 v[68:69], v6, s[20:23], s62 offen offset:1024
    s_mov_b32 s62, 1536
    buffer_load_dwordx2 v[70:71], v6, s[20:23], s62 offen offset:0
    s_mov_b32 s62, 1536
    buffer_load_dwordx2 v[72:73], v6, s[20:23], s62 offen offset:512
    s_mov_b32 s62, 1536
    buffer_load_dwordx2 v[74:75], v6, s[20:23], s62 offen offset:1024
    s_mov_b32 s62, 3072
    buffer_load_dwordx2 v[76:77], v6, s[20:23], s62 offen offset:0
    s_mov_b32 s62, 3072
    buffer_load_dwordx2 v[78:79], v6, s[20:23], s62 offen offset:512
    s_mov_b32 s62, 3072
    buffer_load_dwordx2 v[80:81], v6, s[20:23], s62 offen offset:1024
    s_mov_b32 s62, 4608
    buffer_load_dwordx2 v[82:83], v6, s[20:23], s62 offen offset:0
    s_mov_b32 s62, 4608
    buffer_load_dwordx2 v[84:85], v6, s[20:23], s62 offen offset:512
    s_mov_b32 s62, 4608
    buffer_load_dwordx2 v[86:87], v6, s[20:23], s62 offen offset:1024
    s_mov_b32 s62, 6144
    buffer_load_dwordx2 v[88:89], v6, s[20:23], s62 offen offset:0
    s_mov_b32 s62, 6144
    buffer_load_dwordx2 v[90:91], v6, s[20:23], s62 offen offset:512
    s_mov_b32 s62, 6144
    buffer_load_dwordx2 v[92:93], v6, s[20:23], s62 offen offset:1024
    s_mov_b32 s62, 7680
    buffer_load_dwordx2 v[94:95], v6, s[20:23], s62 offen offset:0
    s_mov_b32 s62, 7680
    buffer_load_dwordx2 v[96:97], v6, s[20:23], s62 offen offset:512
    s_mov_b32 s62, 7680
    buffer_load_dwordx2 v[98:99], v6, s[20:23], s62 offen offset:1024
    s_mov_b32 s62, 9216
    buffer_load_dwordx2 v[100:101], v6, s[20:23], s62 offen offset:0
    s_mov_b32 s62, 9216
    buffer_load_dwordx2 v[102:103], v6, s[20:23], s62 offen offset:512
    s_mov_b32 s62, 9216
    buffer_load_dwordx2 v[104:105], v6, s[20:23], s62 offen offset:1024
    s_mov_b32 s62, 10752
    buffer_load_dwordx2 v[106:107], v6, s[20:23], s62 offen offset:0
    s_mov_b32 s62, 10752
    buffer_load_dwordx2 v[108:109], v6, s[20:23], s62 offen offset:512
    s_mov_b32 s62, 10752
    buffer_load_dwordx2 v[110:111], v6, s[20:23], s62 offen offset:1024
k2_loop:
    s_lshl_b32 s40, s34, 6
    s_add_u32 s40, s38, s40
    s_addc_u32 s41, s39, 0
    s_load_dwordx16 s[44:59], s[40:41], 0
    s_waitcnt lgkmcnt(0)
    s_mul_i32 s42, s44, 768
    s_lshl_b32 s43, s44, 10
    buffer_load_dword v16, v1, s[24:27], s42 offen offset:0
    buffer_load_dword v17, v1, s[24:27], s42 offen offset:256
    buffer_load_dword v18, v1, s[24:27], s42 offen offset:512
    buffer_load_dword v19, v1, s[12:15], s43 offen offset:256
    buffer_load_dword v20, v1, s[12:15], s43 offen offset:512
    buffer_load_dword v21, v1, s[12:15], s43 offen offset:768
    v_mov_b32 v24, 0
    v_mov_b32 v25, 0
    v_mov_b32 v26, 0
    v_mov_b32 v27, 0
    v_mov_b32 v28, 0
    v_mov_b32 v29, 0
    s_waitcnt vmcnt(0)
    s_lshl_b32 s60, s52, 16
    s_and_b32 s61, s52, 0xffff0000
    v_lshlrev_b32 v31, 16, v64
    v_and_b32 v32, 0xffff0000, v64
    v_fma_f32 v24, v31, s60, v24
    v_fma_f32 v24, v32, s61, v24
    v_lshlrev_b32 v31, 16, v65
    v_and_b32 v32, 0xffff0000, v65
    v_fma_f32 v25, v31, s60, v25
    v_fma_f32 v25, v32, s61, v25
    v_lshlrev_b32 v31, 16, v66
    v_and_b32 v32, 0xffff0000, v66
    v_fma_f32 v26, v31, s60, v26
    v_fma_f32 v26, v32, s61, v26
    v_lshlrev_b32 v31, 16, v67
    v_and_b32 v32, 0xffff0000, v67
    v_fma_f32 v27, v31, s60, v27
    v_fma_f32 v27, v32, s61, v27
    v_lshlrev_b32 v31, 16, v68
    v_and_b32 v32, 0xffff0000, v68
    v_fma_f32 v28, v31, s60, v28
    v_fma_f32 v28, v32, s61, v28
    v_lshlrev_b32 v31, 16, v69
    v_and_b32 v32, 0xffff0000, v69
    v_fma_f32 v29, v31, s60, v29
    v_fma_f32 v29, v32, s61, v29
    s_lshl_b32 s60, s53, 16
    s_and_b32 s61, s53, 0xffff0000
    v_lshlrev_b32 v31, 16, v70
    v_and_b32 v32, 0xffff0000, v70
    v_fma_f32 v24, v31, s60, v24
    v_fma_f32 v24, v32, s61, v24
    v_lshlrev_b32 v31, 16, v71
    v_and_b32 v32, 0xffff0000, v71
    v_fma_f32 v25, v31, s60, v25
    v_fma_f32 v25, v32, s61, v25
    v_lshlrev_b32 v31, 16, v72
    v_and_b32 v32, 0xffff0000, v72
    v_fma_f32 v26, v31, s60, v26
    v_fma_f32 v26, v32, s61, v26
    v_lshlrev_b32 v31, 16, v73
    v_and_b32 v32, 0xffff0000, v73
    v_fma_f32 v27, v31, s60, v27
    v_fma_f32 v27, v32, s61, v27
    v_lshlrev_b32 v31, 16, v74
    v_and_b32 v32, 0xffff0000, v74
    v_fma_f32 v28, v31, s60, v28
    v_fma_f32 v28, v32, s61, v28
    v_lshlrev_b32 v31, 16, v75
    v_and_b32 v32, 0xffff0000, v75
    v_fma_f32 v29, v31, s60, v29
    v_fma_f32 v29, v32, s61, v29
    s_lshl_b32 s60, s54, 16
    s_and_b32 s61, s54, 0xffff0000
    v_lshlrev_b32 v31, 16, v76
    v_and_b32 v32, 0xffff0000, v76
    v_fma_f32 v24, v31, s60, v24
    v_fma_f32 v24, v32, s61, v24
    v_lshlrev_b32 v31, 16, v77
    v_and_b32 v32, 0xffff0000, v77
    v_fma_f32 v25, v31, s60, v25
    v_fma_f32 v25, v32, s61, v25
    v_lshlrev_b32 v31, 16, v78
    v_and_b32 v32, 0xffff0000, v78
    v_fma_f32 v26, v31, s60, v26
    v_fma_f32 v26, v32, s61, v26
    v_lshlrev_b32 v31, 16, v79
    v_and_b32 v32, 0xffff0000, v79
    v_fma_f32 v27, v31, s60, v27
    v_fma_f32 v27, v32, s61, v27
    v_lshlrev_b32 v31, 16, v80
    v_and_b32 v32, 0xffff0000, v80
    v_fma_f32 v28, v31, s60, v28
    v_fma_f32 v28, v32, s61, v28
    v_lshlrev_b32 v31, 16, v81
    v_and_b32 v32, 0xffff0000, v81
    v_fma_f32 v29, v31, s60, v29
    v_fma_f32 v29, v32, s61, v29
    s_lshl_b32 s60, s55, 16
    s_and_b32 s61, s55, 0xffff0000
    v_lshlrev_b32 v31, 16, v82
    v_and_b32 v32, 0xffff0000, v82
    v_fma_f32 v24, v31, s60, v24
    v_fma_f32 v24, v32, s61, v24
    v_lshlrev_b32 v31, 16, v83
    v_and_b32 v32, 0xffff0000, v83
    v_fma_f32 v25, v31, s60, v25
    v_fma_f32 v25, v32, s61, v25
    v_lshlrev_b32 v31, 16, v84
    v_and_b32 v32, 0xffff0000, v84
    v_fma_f32 v26, v31, s60, v26
    v_fma_f32 v26, v32, s61, v26
    v_lshlrev_b32 v31, 16, v85
    v_and_b32 v32, 0xffff0000, v85
    v_fma_f32 v27, v31, s60, v27
    v_fma_f32 v27, v32, s61, v27
    v_lshlrev_b32 v31, 16, v86
    v_and_b32 v32, 0xffff0000, v86
    v_fma_f32 v28, v31, s60, v28
    v_fma_f32 v28, v32, s61, v28
    v_lshlrev_b32 v31, 16, v87
    v_and_b32 v32, 0xffff0000, v87
    v_fma_f32 v29, v31, s60, v29
    v_fma_f32 v29, v32, s61, v29
    s_lshl_b32 s60, s56, 16
    s_and_b32 s61, s56, 0xffff0000
    v_lshlrev_b32 v31, 16, v88
    v_and_b32 v32, 0xffff0000, v88
    v_fma_f32 v24, v31, s60, v24
    v_fma_f32 v24, v32, s61, v24
    v_lshlrev_b32 v31, 16, v89
    v_and_b32 v32, 0xffff0000, v89
    v_fma_f32 v25, v31, s60, v25
    v_fma_f32 v25, v32, s61, v25
    v_lshlrev_b32 v31, 16, v90
    v_and_b32 v32, 0xffff0000, v90
    v_fma_f32 v26, v31, s60, v26
    v_fma_f32 v26, v32, s61, v26
    v_lshlrev_b32 v31, 16, v91
    v_and_b32 v32, 0xffff0000, v91
    v_fma_f32 v27, v31, s60, v27
    v_fma_f32 v27, v32, s61, v27
    v_lshlrev_b32 v31, 16, v92
    v_and_b32 v32, 0xffff0000, v92
    v_fma_f32 v28, v31, s60, v28
    v_fma_f32 v28, v32, s61, v28
    v_lshlrev_b32 v31, 16, v93
    v_and_b32 v32, 0xffff0000, v93
    v_fma_f32 v29, v31, s60, v29
    v_fma_f32 v29, v32, s61, v29
    s_lshl_b32 s60, s57, 16
    s_and_b32 s61, s57, 0xffff0000
    v_lshlrev_b32 v31, 16, v94
    v_and_b32 v32, 0xffff0000, v94
    v_fma_f32 v24, v31, s60, v24
    v_fma_f32 v24, v32, s61, v24
    v_lshlrev_b32 v31, 16, v95
    v_and_b32 v32, 0xffff0000, v95
    v_fma_f32 v25, v31, s60, v25
    v_fma_f32 v25, v32, s61, v25
    v_lshlrev_b32 v31, 16, v96
    v_and_b32 v32, 0xffff0000, v96
    v_fma_f32 v26, v31, s60, v26
    v_fma_f32 v26, v32, s61, v26
    v_lshlrev_b32 v31, 16, v97
    v_and_b32 v32, 0xffff0000, v97
    v_fma_f32 v27, v31, s60, v27
    v_fma_f32 v27, v32, s61, v27
    v_lshlrev_b32 v31, 16, v98
    v_and_b32 v32, 0xffff0000, v98
    v_fma_f32 v28, v31, s60, v28
    v_fma_f32 v28, v32, s61, v28
    v_lshlrev_b32 v31, 16, v99
    v_and_b32 v32, 0xffff0000, v99
    v_fma_f32 v29, v31, s60, v29
    v_fma_f32 v29, v32, s61, v29
    s_lshl_b32 s60, s58, 16
    s_and_b32 s61, s58, 0xffff0000
    v_lshlrev_b32 v31, 16, v100
    v_and_b32 v32, 0xffff0000, v100
    v_fma_f32 v24, v31, s60, v24
    v_fma_f32 v24, v32, s61, v24
    v_lshlrev_b32 v31, 16, v101
    v_and_b32 v32, 0xffff0000, v101
    v_fma_f32 v25, v31, s60, v25
    v_fma_f32 v25, v32, s61, v25
    v_lshlrev_b32 v31, 16, v102
    v_and_b32 v32, 0xffff0000, v102
    v_fma_f32 v26, v31, s60, v26
    v_fma_f32 v26, v32, s61, v26
    v_lshlrev_b32 v31, 16, v103
    v_and_b32 v32, 0xffff0000, v103
    v_fma_f32 v27, v31, s60, v27
    v_fma_f32 v27, v32, s61, v27
    v_lshlrev_b32 v31, 16, v104
    v_and_b32 v32, 0xffff0000, v104
    v_fma_f32 v28, v31, s60, v28
    v_fma_f32 v28, v32, s61, v28
    v_lshlrev_b32 v31, 16, v105
    v_and_b32 v32, 0xffff0000, v105
    v_fma_f32 v29, v31, s60, v29
    v_fma_f32 v29, v32, s61, v29
    s_lshl_b32 s60, s59, 16
    s_and_b32 s61, s59, 0xffff0000
    v_lshlrev_b32 v31, 16, v106
    v_and_b32 v32, 0xffff0000, v106
    v_fma_f32 v24, v31, s60, v24
    v_fma_f32 v24, v32, s61, v24
    v_lshlrev_b32 v31, 16, v107
    v_and_b32 v32, 0xffff0000, v107
    v_fma_f32 v25, v31, s60, v25
    v_fma_f32 v25, v32, s61, v25
    v_lshlrev_b32 v31, 16, v108
    v_and_b32 v32, 0xffff0000, v108
    v_fma_f32 v26, v31, s60, v26
    v_fma_f32 v26, v32, s61, v26
    v_lshlrev_b32 v31, 16, v109
    v_and_b32 v32, 0xffff0000, v109
    v_fma_f32 v27, v31, s60, v27
    v_fma_f32 v27, v32, s61, v27
    v_lshlrev_b32 v31, 16, v110
    v_and_b32 v32, 0xffff0000, v110
    v_fma_f32 v28, v31, s60, v28
    v_fma_f32 v28, v32, s61, v28
    v_lshlrev_b32 v31, 16, v111
    v_and_b32 v32, 0xffff0000, v111
    v_fma_f32 v29, v31, s60, v29
    v_fma_f32 v29, v32, s61, v29
    RND2 v24, v25, v30
    v_mul_f32 v24, s49, v24
    v_mul_f32 v25, s49, v25
    RND2 v24, v25, v30
    v_lshlrev_b32 v31, 16, v16
    v_and_b32 v32, 0xffff0000, v16
    v_mul_f32 v24, v24, v31
    v_mul_f32 v25, v25, v32
    RND2 v24, v25, v30
    RND2 v26, v27, v30
    v_mul_f32 v26, s49, v26
    v_mul_f32 v27, s49, v27
    RND2 v26, v27, v30
    v_lshlrev_b32 v31, 16, v17
    v_and_b32 v32, 0xffff0000, v17
    v_mul_f32 v26, v26, v31
    v_mul_f32 v27, v27, v32
    RND2 v26, v27, v30
    RND2 v28, v29, v30
    v_mul_f32 v28, s49, v28
    v_mul_f32 v29, s49, v29
    RND2 v28, v29, v30
    v_lshlrev_b32 v31, 16, v18
    v_and_b32 v32, 0xffff0000, v18
    v_mul_f32 v28, v28, v31
    v_mul_f32 v29, v29, v32
    RND2 v28, v29, v30
    v_add_f32 v8, v8, v24
    v_add_f32 v9, v9, v25
    v_lshlrev_b32 v31, 16, v19
    v_and_b32 v32, 0xffff0000, v19
    v_mul_f32 v31, v26, v31
    v_mul_f32 v32, v27, v32
    RND2 v31, v32, v30
    v_mul_f32 v33, s46, v28
    v_mul_f32 v34, s46, v29
    RND2 v33, v34, v30
    v_add_f32 v31, v31, v33
    v_add_f32 v32, v32, v34
    RND2 v31, v32, v30
    v_add_f32 v10, v10, v31
    v_add_f32 v11, v11, v32
    v_lshlrev_b32 v31, 16, v20
    v_and_b32 v32, 0xffff0000, v20
    v_mul_f32 v31, v26, v31
    v_mul_f32 v32, v27, v32
    RND2 v31, v32, v30
    v_mul_f32 v33, s47, v28
    v_mul_f32 v34, s47, v29
    RND2 v33, v34, v30
    v_add_f32 v31, v31, v33
    v_add_f32 v32, v32, v34
    RND2 v31, v32, v30
    v_add_f32 v12, v12, v31
    v_add_f32 v13, v13, v32
    v_lshlrev_b32 v31, 16, v21
    v_and_b32 v32, 0xffff0000, v21
    v_mul_f32 v31, v26, v31
    v_mul_f32 v32, v27, v32
    RND2 v31, v32, v30
    v_mul_f32 v33, s48, v28
    v_mul_f32 v34, s48, v29
    RND2 v33, v34, v30
    v_add_f32 v31, v31, v33
    v_add_f32 v32, v32, v34
    RND2 v31, v32, v30
    v_add_f32 v14, v14, v31
    v_add_f32 v15, v15, v32
    s_mov_b32 s34, s45
    s_cmp_lg_u32 s34, -1
    s_cbranch_scc1 k2_loop
k2_fin:
    s_waitcnt vmcnt(0)
    RND2 v8, v9, v30
    v_lshlrev_b32 v31, 16, v2
    v_and_b32 v32, 0xffff0000, v2
    v_add_f32 v31, v31, v8
    v_add_f32 v32, v32, v9
    v_cvt_pk_bf16_f32 v2, v31, v32
    buffer_store_dword v2, v1, s[16:19], s11 offen offset:0
    RND2 v10, v11, v30
    v_lshlrev_b32 v31, 16, v3
    v_and_b32 v32, 0xffff0000, v3
    v_add_f32 v31, v31, v10
    v_add_f32 v32, v32, v11
    v_cvt_pk_bf16_f32 v3, v31, v32
    buffer_store_dword v3, v1, s[16:19], s11 offen offset:256
    RND2 v12, v13, v30
    v_lshlrev_b32 v31, 16, v4
    v_and_b32 v32, 0xffff0000, v4
    v_add_f32 v31, v31, v12
    v_add_f32 v32, v32, v13
    v_cvt_pk_bf16_f32 v4, v31, v32
    buffer_store_dword v4, v1, s[16:19], s11 offen offset:512
    RND2 v14, v15, v30
    v_lshlrev_b32 v31, 16, v5
    v_and_b32 v32, 0xffff0000, v5
    v_add_f32 v31, v31, v14
    v_add_f32 v32, v32, v15
    v_cvt_pk_bf16_f32 v5, v31, v32
    buffer_store_dword v5, v1, s[16:19], s11 offen offset:768
k2_end:
    s_endpgm
.section .rodata,"a"
.p2align 6
.amdhsa_kernel k0_kernel
  .amdhsa_next_free_vgpr 32
  .amdhsa_next_free_sgpr 102
  .amdhsa_accum_offset 32
  .amdhsa_group_segment_fixed_size 0
  .amdhsa_kernarg_size 88
  .amdhsa_user_sgpr_count 2
  .amdhsa_user_sgpr_kernarg_segment_ptr 1
  .amdhsa_system_sgpr_workgroup_id_x 1
.end_amdhsa_kernel
.p2align 6
.amdhsa_kernel k1_kernel
  .amdhsa_next_free_vgpr 160
  .amdhsa_next_free_sgpr 102
  .amdhsa_accum_offset 160
  .amdhsa_group_segment_fixed_size 0
  .amdhsa_kernarg_size 88
  .amdhsa_user_sgpr_count 2
  .amdhsa_user_sgpr_kernarg_segment_ptr 1
  .amdhsa_system_sgpr_workgroup_id_x 1
.end_amdhsa_kernel
.p2align 6
.amdhsa_kernel standalone__molecular_angular_painn__graph_kernel
  .amdhsa_next_free_vgpr 112
  .amdhsa_next_free_sgpr 102
  .amdhsa_accum_offset 112
  .amdhsa_group_segment_fixed_size 0
  .amdhsa_kernarg_size 88
  .amdhsa_user_sgpr_count 2
  .amdhsa_user_sgpr_kernarg_segment_ptr 1
  .amdhsa_system_sgpr_workgroup_id_x 1
.end_amdhsa_kernel
```
